```python
import torch

def _softmax(x, axis=-1):
    return torch.softmax(x, dim=axis)

def _gelu(x):
    return torch.nn.functional.gelu(x, approximate='tanh')

def _silu(x):
    return torch.nn.functional.silu(x)

def _sigmoid(x):
    return torch.sigmoid(x)

def _layernorm(x, axis=-1, eps=1e-05):
    m = x.mean(dim=axis, keepdim=True)
    v = x.var(dim=axis, keepdim=True, unbiased=False)
    return (x - m) / torch.sqrt(v + eps)

def _scatter_add(tgt, idx, src, axis=0):
    return tgt.clone().index_add_(axis, idx, src)

def _segment_sum(src, seg, n):
    out = torch.zeros((n,) + src.shape[1:], dtype=src.dtype)
    return out.index_add_(0, seg, src)

def _pad(x, pw):
    flat = tuple((v for pair in reversed(pw) for v in pair))
    return torch.nn.functional.pad(x, flat)
kernel_name = 'adaLN_cond__sliding_block_cached__mixer_channel_mlp__decode'

def setup_inputs():

    _w = lambda a: (lambda t: t.to(torch.bfloat16) if t.is_floating_point() else t)(torch.as_tensor(a))

    def _A_setup():
        B, Sq, D = (1, 1, 576)
        Hq, Hkv, Sk, Dh = (32, 16, 32768, 128)
        assert Hq % Hkv == 0, (Hq, Hkv)
        return {'x': _w((lambda *s: torch.randn(*s, dtype=torch.bfloat16) * 0.1)(B, Sq, D)), 'k_cache': _w((lambda *s: torch.randn(*s, dtype=torch.bfloat16) * 0.8)(B, Hkv, Sk, Dh)), 'v_cache': _w((lambda *s: torch.randn(*s, dtype=torch.bfloat16) * 0.8)(B, Hkv, Sk, Dh)), 'wq': _w((lambda *s: torch.randn(*s, dtype=torch.bfloat16) * 0.8)(D, Hq * Dh) * D ** (-0.5)), 'wo': _w((lambda *s: torch.randn(*s, dtype=torch.bfloat16) * 0.8)(Hq * Dh, D) * (Hq * Dh) ** (-0.5))}
    _A_in = _A_setup()

    def _B_setup():
        B, S, D, F = (1, 1, 576, 4608)
        return {'x': _w((lambda *s: torch.randn(*s, dtype=torch.bfloat16) * 0.1)(B, S, D)), 'w1': _w((lambda *s: torch.randn(*s, dtype=torch.bfloat16) * 3.2)(D, F) * D ** (-0.5)), 'b1': _w((lambda *s: torch.randn(*s, dtype=torch.bfloat16) * 3.2)(F)), 'w2': _w((lambda *s: torch.randn(*s, dtype=torch.bfloat16) * 1.6)(F, D) * F ** (-0.5)), 'b2': _w((lambda *s: torch.randn(*s, dtype=torch.bfloat16) * 1.6)(D))}
    _B_in = _B_setup()
    return {'A_x': _A_in['x'], 'A_k_cache': _A_in['k_cache'], 'A_v_cache': _A_in['v_cache'], 'A_wq': _A_in['wq'], 'A_wo': _A_in['wo'], 'B_x': _B_in['x'], 'B_w1': _B_in['w1'], 'B_b1': _B_in['b1'], 'B_w2': _B_in['w2'], 'B_b2': _B_in['b2'], 'c': _w((lambda *s: torch.randn(*s, dtype=torch.bfloat16) * 0.4)(1, 576) * 8.0), 'w_mod': _w((lambda *s: torch.randn(*s, dtype=torch.bfloat16) * 0.4)(576, 6 * 576) * 576 ** (-0.5) * 8.0)}

def reference(A_x, A_k_cache, A_v_cache, A_wq, A_wo, B_x, B_w1, B_b1, B_w2, B_b2, c, w_mod):

    def _A_ref(x, k_cache, v_cache, wq, wo):
        B, Sq, D = x.shape
        Hq, Dh = (32, 128)
        Hkv, Sk = (k_cache.shape[1], k_cache.shape[2])
        W = min(4096, max(256, Sk // 4))
        rep = Hq // Hkv
        q = (lambda x, *d: x.permute(*d))((x @ wq).reshape(B, Sq, Hq, Dh), 0, 2, 1, 3)
        k = (lambda x, n, axis: torch.repeat_interleave(x, n, dim=axis))(k_cache[:, :, Sk - W:, :], rep, axis=1)
        v = (lambda x, n, axis: torch.repeat_interleave(x, n, dim=axis))(v_cache[:, :, Sk - W:, :], rep, axis=1)
        scores = torch.einsum('bhqd,bhkd->bhqk', q, k) * Dh ** (-0.5)
        p = _softmax(scores, axis=-1)
        o = torch.einsum('bhqk,bhkd->bhqd', p, v)
        return (lambda x, *d: x.permute(*d))(o, 0, 2, 1, 3).reshape(B, Sq, Hq * Dh) @ wo

    def _B_ref(x, w1, b1, w2, b2):
        y = _layernorm(x, axis=-1)
        h = _gelu(torch.einsum('bsd,df->bsf', y, w1) + b1)
        return torch.einsum('bsf,fd->bsd', h, w2) + b2
    x = A_x
    mod = (_silu(c) @ w_mod).reshape(c.shape[0], 6, 1, -1)
    sa, ca, ga, sb, cb, gb = (mod[:, 0].clone(), mod[:, 1].clone(), mod[:, 2].clone(), mod[:, 3].clone(), mod[:, 4].clone(), mod[:, 5].clone())
    h = _layernorm(x, axis=-1) * (1 + ca) + sa
    x = x + ga * _A_ref(h, A_k_cache, A_v_cache, A_wq, A_wo)
    h = _layernorm(x, axis=-1) * (1 + cb) + sb
    x = x + gb * _B_ref(h, B_w1, B_b1, B_w2, B_b2)
    return x
```

```asm
; @launch grid=(256,1,1) block=(512,1,1) lds=9984
.amdgcn_target "amdgcn-amd-amdhsa--gfx950"
.text
.globl adaLN_cond__sliding_block_cached__mixer_channel_mlp__decode_kernel
.p2align 8
.type adaLN_cond__sliding_block_cached__mixer_channel_mlp__decode_kernel,@function
adaLN_cond__sliding_block_cached__mixer_channel_mlp__decode_kernel:
    s_cmp_ge_u32 s2, 256
    s_cbranch_scc1 L_exit
    s_load_dwordx16 s[16:31], s[0:1], 0
    s_load_dwordx8 s[32:39], s[0:1], 64
    s_load_dwordx2 s[40:41], s[0:1], 96
    s_load_dwordx2 s[42:43], s[0:1], 112
    v_cmp_gt_u32 vcc, 256, v0
    v_and_b32 v2, 15, v0
    v_bfe_u32 v1, v0, 4, 2
    s_cbranch_vccnz L_chain
    s_mul_i32 s69, s2, 8392704
    s_mul_i32 s65, s2, 0x1100
    v_lshlrev_b32 v14, 6, v2
    s_and_b32 s69, s69, 0x078f0000
    v_lshl_add_u32 v14, v1, 4, v14
    s_and_b32 s65, s65, 0xf000
    v_bfe_u32 v3, v0, 6, 2
    s_add_u32 s69, s69, 7340032
    v_lshl_add_u32 v14, v3, 10, v14
    s_mov_b32 s46, 65536
    s_mov_b32 s47, 0x20000
    s_waitcnt lgkmcnt(0)
    s_add_u32 s44, s18, s69
    s_addc_u32 s45, s19, 0
    s_cmp_lt_u32 s2, 144
    s_cbranch_scc1 L_main_w
    buffer_load_dwordx4 v[40:43], v14, s[44:47], s65 offen nt
    s_add_u32 s65, s65, 4096
    s_and_b32 s65, s65, 0xffff
    buffer_load_dwordx4 v[44:47], v14, s[44:47], s65 offen nt
    s_add_u32 s65, s65, 4096
    s_and_b32 s65, s65, 0xffff
    buffer_load_dwordx4 v[48:51], v14, s[44:47], s65 offen nt
    s_add_u32 s65, s65, 4096
    s_and_b32 s65, s65, 0xffff
    buffer_load_dwordx4 v[52:55], v14, s[44:47], s65 offen nt
    s_add_u32 s65, s65, 4096
    s_and_b32 s65, s65, 0xffff
    buffer_load_dwordx4 v[56:59], v14, s[44:47], s65 offen nt
    s_add_u32 s65, s65, 4096
    s_and_b32 s65, s65, 0xffff
    buffer_load_dwordx4 v[60:63], v14, s[44:47], s65 offen nt
    s_add_u32 s65, s65, 4096
    s_and_b32 s65, s65, 0xffff
    s_branch L_main_o
L_chain:
    v_lshrrev_b32 v3, 6, v0
    v_and_b32 v0, 63, v0
    v_readfirstlane_b32 s3, v3
    s_and_b32 s4, s2, 15
    s_lshr_b32 s5, s2, 4
    v_mov_b32 v247, 0
    s_cmp_lg_u32 s3, 0
    s_cbranch_scc1 L_s1
    s_setprio 1
    s_and_b32 s70, s4, 7
    s_lshr_b32 s71, s4, 3
    s_mul_i32 s71, s71, 9
    s_add_u32 s71, s71, s5
    v_min_u32 v3, 8, v2
    v_lshl_add_u32 v3, v3, 3, v1
    s_mul_i32 s69, s70, 72
    v_add_lshl_u32 v17, v3, s69, 1
    s_mul_i32 s69, s70, 497664
    s_lshl_b32 s66, s71, 7
    s_add_u32 s69, s69, s66
    v_lshrrev_b32 v3, 3, v2
    v_lshl_add_u32 v3, v3, 2, v1
    v_mul_u32_u24 v3, 6912, v3
    v_and_b32 v14, 7, v2
    v_lshl_add_u32 v14, v14, 4, v3
    s_mov_b32 s67, 0
    s_cmp_ge_u32 s5, 9
    s_waitcnt lgkmcnt(0)
    s_cbranch_scc1 L_c_bar0
    s_add_u32 s44, s38, s69
    s_addc_u32 s45, s39, 0
    s_mov_b32 s46, 497664
    s_mov_b32 s47, 0x20000
    global_load_short_d16_hi v20, v17, s[36:37]
    global_load_short_d16_hi v21, v17, s[36:37] offset:8
    buffer_load_dwordx4 v[40:43], v14, s[44:47], s67 offen nt
    s_add_u32 s67, s67, 55296
    buffer_load_dwordx4 v[44:47], v14, s[44:47], s67 offen nt
    s_add_u32 s67, s67, 55296
    buffer_load_dwordx4 v[48:51], v14, s[44:47], s67 offen nt
    s_add_u32 s67, s67, 55296
    buffer_load_dwordx4 v[52:55], v14, s[44:47], s67 offen nt
    s_add_u32 s67, s67, 55296
    buffer_load_dwordx4 v[56:59], v14, s[44:47], s67 offen nt
    s_add_u32 s67, s67, 55296
    buffer_load_dwordx4 v[60:63], v14, s[44:47], s67 offen nt
    s_add_u32 s67, s67, 55296
    buffer_load_dwordx4 v[64:67], v14, s[44:47], s67 offen nt
    s_add_u32 s67, s67, 55296
    buffer_load_dwordx4 v[68:71], v14, s[44:47], s67 offen nt
    s_add_u32 s67, s67, 55296
    buffer_load_dwordx4 v[72:75], v14, s[44:47], s67 offen nt
L_c_bar0:
    s_load_dword s8, s[42:43], 0
    s_mov_b64 s[60:61], s[42:43]
    s_mov_b32 s62, 1048576
    s_mov_b32 s63, 0x20000
    s_barrier
    s_branch L_c_post
L_s1:
    s_cmp_ge_u32 s3, 3
    s_cbranch_scc1 L_s3
    s_setprio 1
    v_lshlrev_b32 v17, 3, v0
    v_lshlrev_b32 v18, 3, v2
    v_lshl_add_u32 v3, v2, 2, v1
    s_lshl_b32 s69, s5, 6
    v_add_lshl_u32 v3, v3, s69, 1
    s_lshl_b32 s69, s5, 19
    s_lshl_b32 s66, s4, 9
    s_add_u32 s69, s69, s66
    s_lshl_b32 s66, s3, 8
    s_add_u32 s69, s69, s66
    s_sub_u32 s69, s69, 256
    v_lshlrev_b32 v14, 13, v1
    v_lshl_add_u32 v14, v2, 4, v14
    s_mov_b32 s67, 0
    s_cmp_ge_u32 s5, 9
    s_waitcnt lgkmcnt(0)
    s_cbranch_scc1 L_c_bar1
    s_add_u32 s44, s22, s69
    s_addc_u32 s45, s23, 0
    s_mov_b32 s46, 524288
    s_mov_b32 s47, 0x20000
    global_load_dwordx2 v[20:21], v17, s[16:17]
    global_load_dwordx2 v[22:23], v17, s[16:17] offset:512
    global_load_dwordx2 v[24:25], v18, s[16:17] offset:1024
    global_load_short_d16_hi v26, v3, s[16:17]
    buffer_load_dwordx4 v[40:43], v14, s[44:47], s67 offen nt
    s_add_u32 s67, s67, 32768
    buffer_load_dwordx4 v[44:47], v14, s[44:47], s67 offen nt
    s_add_u32 s67, s67, 32768
    buffer_load_dwordx4 v[48:51], v14, s[44:47], s67 offen nt
    s_add_u32 s67, s67, 32768
    buffer_load_dwordx4 v[52:55], v14, s[44:47], s67 offen nt
    s_add_u32 s67, s67, 32768
    buffer_load_dwordx4 v[56:59], v14, s[44:47], s67 offen nt
    s_add_u32 s67, s67, 32768
    buffer_load_dwordx4 v[60:63], v14, s[44:47], s67 offen nt
    s_add_u32 s67, s67, 32768
    buffer_load_dwordx4 v[64:67], v14, s[44:47], s67 offen nt
    s_add_u32 s67, s67, 32768
    buffer_load_dwordx4 v[68:71], v14, s[44:47], s67 offen nt
    s_add_u32 s67, s67, 32768
    buffer_load_dwordx4 v[72:75], v14, s[44:47], s67 offen nt
    s_add_u32 s67, s67, 32768
    buffer_load_dwordx4 v[76:79], v14, s[44:47], s67 offen nt
    s_add_u32 s67, s67, 32768
    buffer_load_dwordx4 v[80:83], v14, s[44:47], s67 offen nt
    s_add_u32 s67, s67, 32768
    buffer_load_dwordx4 v[84:87], v14, s[44:47], s67 offen nt
    s_add_u32 s67, s67, 32768
    buffer_load_dwordx4 v[88:91], v14, s[44:47], s67 offen nt
    s_add_u32 s67, s67, 32768
    buffer_load_dwordx4 v[92:95], v14, s[44:47], s67 offen nt
    s_add_u32 s67, s67, 32768
    buffer_load_dwordx4 v[96:99], v14, s[44:47], s67 offen nt
    s_add_u32 s67, s67, 32768
    buffer_load_dwordx4 v[100:103], v14, s[44:47], s67 offen nt
L_c_bar1:
    s_load_dword s8, s[42:43], 0
    s_mov_b64 s[60:61], s[42:43]
    s_mov_b32 s62, 1048576
    s_mov_b32 s63, 0x20000
    s_barrier
    s_branch L_c_post
L_s3:
    v_mov_b32 v20, 0
    v_mov_b32 v21, 0
    v_mov_b32 v22, 0
    v_mov_b32 v23, 0
    v_lshlrev_b32 v3, 4, v2
    ds_write_b128 v3, v[20:23]
    s_getpc_b64 s[70:71]
L_pc:
    s_bfe_u32 s69, s2, 0x20003
    s_min_u32 s69, s69, 2
    s_lshl_b32 s69, s69, 13
    v_lshl_add_u32 v3, v0, 7, s69
    v_min_u32 v3, L_exit-L_pc, v3
    global_load_dword v239, v3, s[70:71]
    s_waitcnt lgkmcnt(0)
    s_load_dword s8, s[42:43], 0
    s_mov_b64 s[60:61], s[42:43]
    s_mov_b32 s62, 1048576
    s_mov_b32 s63, 0x20000
    s_barrier
    s_branch L_c_post
L_main_o:
    v_and_b32 v15, 255, v0
    v_lshlrev_b32 v15, 4, v15
    s_add_u32 s48, s20, s69
    s_addc_u32 s49, s21, 0
    s_mov_b32 s50, 65536
    s_mov_b32 s51, 0x20000
    v_lshrrev_b32 v3, 6, v0
    v_and_b32 v0, 63, v0
    v_readfirstlane_b32 s3, v3
    s_and_b32 s4, s2, 15
    s_lshr_b32 s5, s2, 4
    v_mov_b32 v247, 0
    s_sub_u32 s96, s3, 4
    v_mov_b32 v16, 0
    s_load_dword s8, s[42:43], 0
    s_mov_b64 s[60:61], s[42:43]
    s_mov_b32 s62, 1048576
    s_mov_b32 s63, 0x20000
    s_barrier
    s_sub_u32 s69, s2, 216
    s_cmp_ge_u32 s69, 36
    s_cselect_b32 s6, 3, 2
    s_and_b32 s70, s4, 7
    s_lshr_b32 s71, s4, 3
    s_mul_i32 s7, s70, 9
    s_add_u32 s7, s7, s71
    s_cmp_eq_u32 s5, 13
    s_cselect_b32 s69, s70, s69
    s_cselect_b32 s6, 2, s6
    s_lshl_b32 s70, s5, 1
    s_add_u32 s7, s7, s70
    s_sub_u32 s7, s7, 18
    s_cmp_lt_u32 s2, 216
    s_cselect_b32 s7, s7, s69
    s_cselect_b32 s6, 1, s6
    s_cmp_lt_u32 s5, 9
    s_cselect_b32 s7, s5, s7
    s_cselect_b32 s6, 0, s6
    v_and_b32 v3, 1, v2
    v_lshlrev_b32 v3, 4, v3
    v_mov_b32 v8, 0xffff
    v_lshlrev_b32 v3, v3, v8
    v_bfe_u32 v8, v2, 1, 2
    v_cmp_eq_u32 vcc, 0, v8
    s_nop 1
    v_cndmask_b32 v4, 0, v3, vcc
    v_cmp_eq_u32 vcc, 1, v8
    s_nop 1
    v_cndmask_b32 v5, 0, v3, vcc
    v_cmp_eq_u32 vcc, 2, v8
    s_nop 1
    v_cndmask_b32 v6, 0, v3, vcc
    v_cmp_eq_u32 vcc, 3, v8
    s_nop 1
    v_cndmask_b32 v7, 0, v3, vcc
    v_lshrrev_b32 v3, 3, v2
    s_mov_b32 s69, 0x02020202
    v_mul_lo_u32 v3, v3, s69
    v_add_u32 v3, 0x01000100, v3
    s_mov_b32 s69, 0x0c0c0c0c
    v_bfi_b32 v8, v4, v3, s69
    v_bfi_b32 v9, v5, v3, s69
    v_bfi_b32 v10, v6, v3, s69
    v_bfi_b32 v11, v7, v3, s69
    v_lshlrev_b32 v246, 5, v2
    v_lshl_add_u32 v246, v1, 4, v246
    s_waitcnt lgkmcnt(0)
    s_mul_i32 s69, s8, 0x9E3779B1
    s_add_u32 s69, s69, 0x7F4A7C15
    s_or_b32 s69, s69, 0x01010101
    s_xor_b32 s8, s8, s69
    s_lshr_b32 s9, s8, 8
    s_lshr_b32 s10, s8, 16
    s_lshr_b32 s11, s8, 24
    s_mov_b32 s12, 0x7060500
    s_mov_b32 s13, 0x7060501
    s_mov_b32 s14, 0x7060502
    s_mov_b32 s15, 0x7060503
    v_mov_b32 v12, s8
    v_lshlrev_b32 v13, 3, v1
    v_lshrrev_b32 v13, v13, v12
    v_and_b32 v245, 1, v1
    v_lshl_add_u32 v244, v2, 1, v245
    v_lshlrev_b32 v244, 3, v244
    v_lshrrev_b32 v244, v244, v12
    v_lshlrev_b32 v245, 3, v2
    v_lshrrev_b32 v245, v245, v12
    v_and_b32 v3, 3, v2
    v_lshl_add_u32 v3, v3, 2, v1
    v_lshlrev_b32 v3, 4, v3
    v_lshrrev_b32 v18, 3, v2
    v_lshl_add_u32 v3, v18, 8, v3
    v_add_u32 v3, 256, v3
    v_and_b32 v19, 4, v2
    v_cmp_eq_u32 vcc, 0, v19
    v_mov_b32 v19, 48
    s_nop 0
    v_cndmask_b32 v28, v19, v3, vcc
    v_cndmask_b32 v29, v3, v19, vcc
    s_lshl_b32 s70, s96, 2
    v_lshl_add_u32 v19, v18, 4, s70
    v_lshrrev_b32 v17, 1, v1
    v_lshlrev_b32 v17, 4, v17
    s_lshl_b32 s70, s4, 4
    s_add_u32 s70, s70, s5
    s_mul_i32 s70, s70, 1152
    s_add_u32 s97, s70, 524288
    v_and_b32 v3, 1, v1
    v_lshlrev_b32 v18, 5, v17
    v_lshl_add_u32 v18, v3, 4, v18
    v_lshl_add_u32 v18, v2, 5, v18
    s_waitcnt vmcnt(5)
    buffer_load_dwordx4 v[64:67], v14, s[44:47], s65 offen nt
    s_add_u32 s65, s65, 4096
    s_and_b32 s65, s65, 0xffff
    s_waitcnt vmcnt(5)
    buffer_load_dwordx4 v[68:71], v14, s[44:47], s65 offen nt
    s_add_u32 s65, s65, 4096
    s_and_b32 s65, s65, 0xffff
    s_waitcnt vmcnt(5)
    buffer_load_dwordx4 v[72:75], v14, s[44:47], s65 offen nt
    s_add_u32 s65, s65, 4096
    s_and_b32 s65, s65, 0xffff
    s_waitcnt vmcnt(5)
    buffer_load_dwordx4 v[76:79], v14, s[44:47], s65 offen nt
    s_add_u32 s65, s65, 4096
    s_and_b32 s65, s65, 0xffff
    s_waitcnt vmcnt(5)
    buffer_load_dwordx4 v[80:83], v14, s[44:47], s65 offen nt
    s_add_u32 s65, s65, 4096
    s_and_b32 s65, s65, 0xffff
    s_waitcnt vmcnt(5)
    buffer_load_dwordx4 v[84:87], v14, s[44:47], s65 offen nt
    s_add_u32 s65, s65, 4096
    s_and_b32 s65, s65, 0xffff
    s_waitcnt vmcnt(5)
    buffer_load_dwordx4 v[88:91], v14, s[44:47], s65 offen nt
    s_add_u32 s65, s65, 4096
    s_and_b32 s65, s65, 0xffff
    s_waitcnt vmcnt(5)
    buffer_load_dwordx4 v[92:95], v14, s[44:47], s65 offen nt
    s_add_u32 s65, s65, 4096
    s_and_b32 s65, s65, 0xffff
    s_waitcnt vmcnt(5)
    buffer_load_dwordx4 v[96:99], v14, s[44:47], s65 offen nt
    s_add_u32 s65, s65, 4096
    s_and_b32 s65, s65, 0xffff
    s_waitcnt vmcnt(5)
    buffer_load_dwordx4 v[100:103], v14, s[44:47], s65 offen nt
    s_add_u32 s65, s65, 4096
    s_and_b32 s65, s65, 0xffff
    v_mov_b32 v30, 1
    s_mov_b64 exec, 1
    ds_add_u32 v247, v30 offset:4
    s_mov_b64 exec, -1
    s_waitcnt vmcnt(5)
    buffer_load_dwordx4 v[104:107], v15, s[48:51], s65 offen nt
    s_add_u32 s65, s65, 4096
    s_and_b32 s65, s65, 0xffff
    s_waitcnt vmcnt(5)
    buffer_load_dwordx4 v[108:111], v15, s[48:51], s65 offen nt
    s_add_u32 s65, s65, 4096
    s_and_b32 s65, s65, 0xffff
    s_waitcnt vmcnt(5)
    buffer_load_dwordx4 v[112:115], v15, s[48:51], s65 offen nt
    s_add_u32 s65, s65, 4096
    s_and_b32 s65, s65, 0xffff
    s_waitcnt vmcnt(5)
    buffer_load_dwordx4 v[116:119], v15, s[48:51], s65 offen nt
    s_add_u32 s65, s65, 4096
    s_and_b32 s65, s65, 0xffff
    s_waitcnt vmcnt(5)
    buffer_load_dwordx4 v[120:123], v15, s[48:51], s65 offen nt
    s_add_u32 s65, s65, 4096
    s_and_b32 s65, s65, 0xffff
    s_waitcnt vmcnt(5)
    buffer_load_dwordx4 v[124:127], v15, s[48:51], s65 offen nt
    s_add_u32 s65, s65, 4096
    s_and_b32 s65, s65, 0xffff
    s_waitcnt vmcnt(5)
    buffer_load_dwordx4 v[128:131], v15, s[48:51], s65 offen nt
    s_add_u32 s65, s65, 4096
    s_and_b32 s65, s65, 0xffff
    s_waitcnt vmcnt(5)
    buffer_load_dwordx4 v[132:135], v15, s[48:51], s65 offen nt
    s_add_u32 s65, s65, 4096
    s_and_b32 s65, s65, 0xffff
    s_waitcnt vmcnt(5)
    buffer_load_dwordx4 v[136:139], v15, s[48:51], s65 offen nt
    s_add_u32 s65, s65, 4096
    s_and_b32 s65, s65, 0xffff
    s_waitcnt vmcnt(5)
    buffer_load_dwordx4 v[140:143], v15, s[48:51], s65 offen nt
    s_add_u32 s65, s65, 4096
    s_and_b32 s65, s65, 0xffff
    s_waitcnt vmcnt(5)
    buffer_load_dwordx4 v[144:147], v15, s[48:51], s65 offen nt
    s_add_u32 s65, s65, 4096
    s_and_b32 s65, s65, 0xffff
    s_waitcnt vmcnt(5)
    buffer_load_dwordx4 v[148:151], v15, s[48:51], s65 offen nt
    s_add_u32 s65, s65, 4096
    s_and_b32 s65, s65, 0xffff
    s_waitcnt vmcnt(5)
    buffer_load_dwordx4 v[152:155], v15, s[48:51], s65 offen nt
    s_add_u32 s65, s65, 4096
    s_and_b32 s65, s65, 0xffff
    s_waitcnt vmcnt(5)
    buffer_load_dwordx4 v[156:159], v15, s[48:51], s65 offen nt
    s_add_u32 s65, s65, 4096
    s_and_b32 s65, s65, 0xffff
    s_waitcnt vmcnt(5)
    buffer_load_dwordx4 v[160:163], v15, s[48:51], s65 offen nt
    s_add_u32 s65, s65, 4096
    s_and_b32 s65, s65, 0xffff
    s_waitcnt vmcnt(5)
    buffer_load_dwordx4 v[164:167], v15, s[48:51], s65 offen nt
    s_add_u32 s65, s65, 4096
    s_and_b32 s65, s65, 0xffff
    s_mov_b64 s[52:53], s[24:25]
    s_mov_b32 s54, 0
    s_mov_b32 s55, 0x20000
    s_mov_b32 s66, 0
    s_mov_b32 s64, 0
    s_branch L_main_j
L_main_w:
    v_and_b32 v15, 255, v0
    v_lshlrev_b32 v15, 4, v15
    s_add_u32 s48, s20, s69
    s_addc_u32 s49, s21, 0
    s_mov_b32 s50, 65536
    s_mov_b32 s51, 0x20000
    v_lshrrev_b32 v3, 6, v0
    v_and_b32 v0, 63, v0
    v_readfirstlane_b32 s3, v3
    s_and_b32 s4, s2, 15
    s_lshr_b32 s5, s2, 4
    v_mov_b32 v247, 0
    s_sub_u32 s96, s3, 4
    v_mov_b32 v16, 0
    s_load_dword s8, s[42:43], 0
    s_mov_b64 s[60:61], s[42:43]
    s_mov_b32 s62, 1048576
    s_mov_b32 s63, 0x20000
    s_barrier
    s_mov_b32 s6, 0
    s_lshl_b32 s69, s4, 2
    s_add_u32 s69, s69, s96
    s_mul_i32 s69, s69, 73728
    s_lshl_b32 s70, s5, 7
    s_add_u32 s69, s69, s70
    s_add_u32 s52, s24, s69
    s_addc_u32 s53, s25, 0
    s_mov_b32 s54, 73728
    s_mov_b32 s55, 0x20000
    s_mov_b32 s64, 4608
    s_mov_b32 s70, 1152
    s_mov_b32 s71, 36864
    v_and_b32 v3, 7, v2
    v_lshlrev_b32 v3, 4, v3
    v_lshrrev_b32 v18, 3, v2
    v_mad_u32_u24 v16, v1, s70, v3
    v_mad_u32_u24 v16, v18, s71, v16
    s_mov_b32 s66, 0
    s_mov_b32 s67, 0
    v_and_b32 v3, 1, v2
    v_lshlrev_b32 v3, 4, v3
    v_mov_b32 v8, 0xffff
    v_lshlrev_b32 v3, v3, v8
    v_bfe_u32 v8, v2, 1, 2
    v_cmp_eq_u32 vcc, 0, v8
    s_nop 1
    v_cndmask_b32 v4, 0, v3, vcc
    v_cmp_eq_u32 vcc, 1, v8
    s_nop 1
    v_cndmask_b32 v5, 0, v3, vcc
    v_cmp_eq_u32 vcc, 2, v8
    s_nop 1
    v_cndmask_b32 v6, 0, v3, vcc
    v_cmp_eq_u32 vcc, 3, v8
    s_nop 1
    v_cndmask_b32 v7, 0, v3, vcc
    v_lshrrev_b32 v3, 3, v2
    s_mov_b32 s69, 0x02020202
    v_mul_lo_u32 v3, v3, s69
    v_add_u32 v3, 0x01000100, v3
    s_mov_b32 s69, 0x0c0c0c0c
    v_bfi_b32 v8, v4, v3, s69
    v_bfi_b32 v9, v5, v3, s69
    v_bfi_b32 v10, v6, v3, s69
    v_bfi_b32 v11, v7, v3, s69
    v_lshlrev_b32 v246, 5, v2
    v_lshl_add_u32 v246, v1, 4, v246
    s_waitcnt lgkmcnt(0)
    s_mul_i32 s69, s8, 0x9E3779B1
    s_add_u32 s69, s69, 0x7F4A7C15
    s_or_b32 s69, s69, 0x01010101
    s_xor_b32 s8, s8, s69
    s_lshr_b32 s9, s8, 8
    s_lshr_b32 s10, s8, 16
    s_lshr_b32 s11, s8, 24
    s_mov_b32 s12, 0x7060500
    s_mov_b32 s13, 0x7060501
    s_mov_b32 s14, 0x7060502
    s_mov_b32 s15, 0x7060503
    v_mov_b32 v12, s8
    v_lshlrev_b32 v13, 3, v1
    v_lshrrev_b32 v13, v13, v12
    v_and_b32 v245, 1, v1
    v_lshl_add_u32 v244, v2, 1, v245
    v_lshlrev_b32 v244, 3, v244
    v_lshrrev_b32 v244, v244, v12
    v_lshlrev_b32 v245, 3, v2
    v_lshrrev_b32 v245, v245, v12
    v_and_b32 v3, 3, v2
    v_lshl_add_u32 v3, v3, 2, v1
    v_lshlrev_b32 v3, 4, v3
    v_lshrrev_b32 v18, 3, v2
    v_lshl_add_u32 v3, v18, 8, v3
    v_add_u32 v3, 256, v3
    v_and_b32 v19, 4, v2
    v_cmp_eq_u32 vcc, 0, v19
    v_mov_b32 v19, 48
    s_nop 0
    v_cndmask_b32 v28, v19, v3, vcc
    v_cndmask_b32 v29, v3, v19, vcc
    s_lshl_b32 s70, s96, 2
    v_lshl_add_u32 v19, v18, 4, s70
    v_lshrrev_b32 v17, 1, v1
    v_lshlrev_b32 v17, 4, v17
    s_lshl_b32 s70, s4, 4
    s_add_u32 s70, s70, s5
    s_mul_i32 s70, s70, 1152
    s_add_u32 s97, s70, 524288
    v_and_b32 v3, 1, v1
    v_lshlrev_b32 v18, 5, v17
    v_lshl_add_u32 v18, v3, 4, v18
    v_lshl_add_u32 v18, v2, 5, v18
    s_mov_b32 s68, 800000
lw_1:
    ds_read_b32 v30, v247 offset:36
    s_waitcnt lgkmcnt(0)
    v_cmp_le_u32 vcc, 1, v30
    s_cbranch_vccnz lwd_2
    s_sleep 1
    s_sub_u32 s68, s68, 1
    s_cbranch_scc0 lw_1
lwd_2:
    buffer_load_dwordx4 v[40:43], v14, s[44:47], s65 offen nt
    s_add_u32 s65, s65, 4096
    s_and_b32 s65, s65, 0xffff
    buffer_load_dwordx4 v[44:47], v14, s[44:47], s65 offen nt
    s_add_u32 s65, s65, 4096
    s_and_b32 s65, s65, 0xffff
    buffer_load_dwordx4 v[48:51], v14, s[44:47], s65 offen nt
    s_add_u32 s65, s65, 4096
    s_and_b32 s65, s65, 0xffff
    buffer_load_dwordx4 v[52:55], v14, s[44:47], s65 offen nt
    s_add_u32 s65, s65, 4096
    s_and_b32 s65, s65, 0xffff
    buffer_load_dwordx4 v[56:59], v14, s[44:47], s65 offen nt
    s_add_u32 s65, s65, 4096
    s_and_b32 s65, s65, 0xffff
    s_waitcnt vmcnt(4)
    buffer_load_dwordx4 v[60:63], v14, s[44:47], s65 offen nt
    s_add_u32 s65, s65, 4096
    s_and_b32 s65, s65, 0xffff
    s_waitcnt vmcnt(4)
    buffer_load_dwordx4 v[64:67], v14, s[44:47], s65 offen nt
    s_add_u32 s65, s65, 4096
    s_and_b32 s65, s65, 0xffff
    s_waitcnt vmcnt(4)
    buffer_load_dwordx4 v[68:71], v14, s[44:47], s65 offen nt
    s_add_u32 s65, s65, 4096
    s_and_b32 s65, s65, 0xffff
    s_waitcnt vmcnt(4)
    buffer_load_dwordx4 v[72:75], v14, s[44:47], s65 offen nt
    s_add_u32 s65, s65, 4096
    s_and_b32 s65, s65, 0xffff
    s_waitcnt vmcnt(4)
    buffer_load_dwordx4 v[76:79], v14, s[44:47], s65 offen nt
    s_add_u32 s65, s65, 4096
    s_and_b32 s65, s65, 0xffff
    s_waitcnt vmcnt(4)
    buffer_load_dwordx4 v[80:83], v14, s[44:47], s65 offen nt
    s_add_u32 s65, s65, 4096
    s_and_b32 s65, s65, 0xffff
    s_waitcnt vmcnt(4)
    buffer_load_dwordx4 v[84:87], v14, s[44:47], s65 offen nt
    s_add_u32 s65, s65, 4096
    s_and_b32 s65, s65, 0xffff
    s_waitcnt vmcnt(4)
    buffer_load_dwordx4 v[88:91], v14, s[44:47], s65 offen nt
    s_add_u32 s65, s65, 4096
    s_and_b32 s65, s65, 0xffff
    s_waitcnt vmcnt(4)
    buffer_load_dwordx4 v[92:95], v14, s[44:47], s65 offen nt
    s_add_u32 s65, s65, 4096
    s_and_b32 s65, s65, 0xffff
    s_mov_b32 s68, 800000
lw_3:
    ds_read_b32 v30, v247 offset:4
    s_waitcnt lgkmcnt(0)
    v_cmp_le_u32 vcc, 2, v30
    s_cbranch_vccnz lwd_4
    s_sleep 1
    s_sub_u32 s68, s68, 1
    s_cbranch_scc0 lw_3
lwd_4:
    s_waitcnt vmcnt(4)
    buffer_load_dwordx4 v[96:99], v14, s[44:47], s65 offen nt
    s_add_u32 s65, s65, 4096
    s_and_b32 s65, s65, 0xffff
    s_waitcnt vmcnt(4)
    buffer_load_dwordx4 v[100:103], v14, s[44:47], s65 offen nt
    s_add_u32 s65, s65, 4096
    s_and_b32 s65, s65, 0xffff
    s_waitcnt vmcnt(4)
    buffer_load_dwordx4 v[104:107], v15, s[48:51], s65 offen nt
    s_add_u32 s65, s65, 4096
    s_and_b32 s65, s65, 0xffff
    s_waitcnt vmcnt(4)
    buffer_load_dwordx4 v[108:111], v15, s[48:51], s65 offen nt
    s_add_u32 s65, s65, 4096
    s_and_b32 s65, s65, 0xffff
    s_waitcnt vmcnt(9)
    buffer_load_dwordx4 v[112:115], v15, s[48:51], s65 offen nt
    s_add_u32 s65, s65, 4096
    s_and_b32 s65, s65, 0xffff
    s_waitcnt vmcnt(9)
    buffer_load_dwordx4 v[116:119], v15, s[48:51], s65 offen nt
    s_add_u32 s65, s65, 4096
    s_and_b32 s65, s65, 0xffff
    s_waitcnt vmcnt(9)
    buffer_load_dwordx4 v[120:123], v15, s[48:51], s65 offen nt
    s_add_u32 s65, s65, 4096
    s_and_b32 s65, s65, 0xffff
    s_waitcnt vmcnt(9)
    buffer_load_dwordx4 v[124:127], v15, s[48:51], s65 offen nt
    s_add_u32 s65, s65, 4096
    s_and_b32 s65, s65, 0xffff
    s_waitcnt vmcnt(9)
    buffer_load_dwordx4 v[128:131], v15, s[48:51], s65 offen nt
    s_add_u32 s65, s65, 4096
    s_and_b32 s65, s65, 0xffff
    s_waitcnt vmcnt(9)
    buffer_load_dwordx4 v[132:135], v15, s[48:51], s65 offen nt
    s_add_u32 s65, s65, 4096
    s_and_b32 s65, s65, 0xffff
    s_waitcnt vmcnt(9)
    buffer_load_dwordx4 v[136:139], v15, s[48:51], s65 offen nt
    s_add_u32 s65, s65, 4096
    s_and_b32 s65, s65, 0xffff
    s_waitcnt vmcnt(9)
    buffer_load_dwordx4 v[140:143], v15, s[48:51], s65 offen nt
    s_add_u32 s65, s65, 4096
    s_and_b32 s65, s65, 0xffff
    s_waitcnt vmcnt(9)
    buffer_load_dwordx4 v[144:147], v15, s[48:51], s65 offen nt
    s_add_u32 s65, s65, 4096
    s_and_b32 s65, s65, 0xffff
    s_waitcnt vmcnt(9)
    buffer_load_dwordx4 v[148:151], v15, s[48:51], s65 offen nt
    s_add_u32 s65, s65, 4096
    s_and_b32 s65, s65, 0xffff
    s_waitcnt vmcnt(9)
    buffer_load_dwordx4 v[152:155], v15, s[48:51], s65 offen nt
    s_add_u32 s65, s65, 4096
    s_and_b32 s65, s65, 0xffff
    s_waitcnt vmcnt(9)
    buffer_load_dwordx4 v[156:159], v15, s[48:51], s65 offen nt
    s_add_u32 s65, s65, 4096
    s_and_b32 s65, s65, 0xffff
    buffer_load_dwordx4 v[160:163], v15, s[48:51], s65 offen nt
    s_add_u32 s65, s65, 4096
    s_and_b32 s65, s65, 0xffff
    buffer_load_dwordx4 v[164:167], v15, s[48:51], s65 offen nt
    s_add_u32 s65, s65, 4096
    s_and_b32 s65, s65, 0xffff
L_main_j:
    buffer_load_dwordx4 v[168:171], v16, s[52:55], s66 offen nt
    s_add_u32 s66, s66, s64
    buffer_load_dwordx4 v[172:175], v16, s[52:55], s66 offen nt
    s_add_u32 s66, s66, s64
    buffer_load_dwordx4 v[176:179], v16, s[52:55], s66 offen nt
    s_add_u32 s66, s66, s64
    s_mov_b32 s44, 0x22222222
    s_mov_b32 s45, 0x22222222
    s_mov_b32 s46, 0x44444444
    s_mov_b32 s47, 0x44444444
    s_mov_b32 s48, 0x88888888
    s_mov_b32 s49, 0x88888888
    s_mov_b32 s70, 0x3db504f3
    s_mov_b32 s71, 0x3fb8aa3b
    s_mov_b32 s68, 800000
lw_5:
    ds_read_b32 v30, v247 offset:0
    s_waitcnt lgkmcnt(0)
    v_cmp_le_u32 vcc, 4, v30
    s_cbranch_vccnz lwd_6
    s_sleep 1
    s_sub_u32 s68, s68, 1
    s_cbranch_scc0 lw_5
lwd_6:
    ds_read_b128 v[20:23], v28
    ds_read_b128 v[24:27], v29
    s_waitcnt vmcnt(19) lgkmcnt(1)
    v_mfma_f32_16x16x32_bf16 v[40:43], v[40:43], v[20:23], 0
    v_mfma_f32_16x16x32_bf16 v[44:47], v[44:47], v[20:23], 0
    v_mfma_f32_16x16x32_bf16 v[48:51], v[48:51], v[20:23], 0
    v_mfma_f32_16x16x32_bf16 v[52:55], v[52:55], v[20:23], 0
    v_mfma_f32_16x16x32_bf16 v[72:75], v[72:75], v[20:23], 0
    v_mfma_f32_16x16x32_bf16 v[76:79], v[76:79], v[20:23], 0
    v_mfma_f32_16x16x32_bf16 v[80:83], v[80:83], v[20:23], 0
    v_mfma_f32_16x16x32_bf16 v[84:87], v[84:87], v[20:23], 0
    s_waitcnt lgkmcnt(0)
    v_mfma_f32_16x16x32_bf16 v[40:43], v[56:59], v[24:27], v[40:43]
    v_mfma_f32_16x16x32_bf16 v[44:47], v[60:63], v[24:27], v[44:47]
    v_mfma_f32_16x16x32_bf16 v[48:51], v[64:67], v[24:27], v[48:51]
    v_mfma_f32_16x16x32_bf16 v[52:55], v[68:71], v[24:27], v[52:55]
    v_mfma_f32_16x16x32_bf16 v[72:75], v[88:91], v[24:27], v[72:75]
    v_mfma_f32_16x16x32_bf16 v[76:79], v[92:95], v[24:27], v[76:79]
    v_mfma_f32_16x16x32_bf16 v[80:83], v[96:99], v[24:27], v[80:83]
    v_mfma_f32_16x16x32_bf16 v[84:87], v[100:103], v[24:27], v[84:87]
    s_nop 0
    v_mov_b32_dpp v40, v40 quad_perm:[0,0,0,0] row_mask:0xf bank_mask:0xf
    v_mov_b32_dpp v44, v44 quad_perm:[0,0,0,0] row_mask:0xf bank_mask:0xf
    v_mov_b32_dpp v48, v48 quad_perm:[0,0,0,0] row_mask:0xf bank_mask:0xf
    v_mov_b32_dpp v52, v52 quad_perm:[0,0,0,0] row_mask:0xf bank_mask:0xf
    v_add_f32_dpp v40, v41, v40 quad_perm:[1,1,1,1] row_mask:0xf bank_mask:0xf
    v_add_f32_dpp v44, v45, v44 quad_perm:[1,1,1,1] row_mask:0xf bank_mask:0xf
    v_add_f32_dpp v48, v49, v48 quad_perm:[1,1,1,1] row_mask:0xf bank_mask:0xf
    v_add_f32_dpp v52, v53, v52 quad_perm:[1,1,1,1] row_mask:0xf bank_mask:0xf
    v_add_f32_dpp v40, v42, v40 quad_perm:[2,2,2,2] row_mask:0xf bank_mask:0xf
    v_add_f32_dpp v44, v46, v44 quad_perm:[2,2,2,2] row_mask:0xf bank_mask:0xf
    v_add_f32_dpp v48, v50, v48 quad_perm:[2,2,2,2] row_mask:0xf bank_mask:0xf
    v_add_f32_dpp v52, v54, v52 quad_perm:[2,2,2,2] row_mask:0xf bank_mask:0xf
    v_add_f32_dpp v40, v43, v40 quad_perm:[3,3,3,3] row_mask:0xf bank_mask:0xf
    v_add_f32_dpp v44, v47, v44 quad_perm:[3,3,3,3] row_mask:0xf bank_mask:0xf
    v_add_f32_dpp v48, v51, v48 quad_perm:[3,3,3,3] row_mask:0xf bank_mask:0xf
    v_add_f32_dpp v52, v55, v52 quad_perm:[3,3,3,3] row_mask:0xf bank_mask:0xf
    v_mov_b32_dpp v72, v72 quad_perm:[0,0,0,0] row_mask:0xf bank_mask:0xf
    v_mov_b32_dpp v76, v76 quad_perm:[0,0,0,0] row_mask:0xf bank_mask:0xf
    v_mov_b32_dpp v80, v80 quad_perm:[0,0,0,0] row_mask:0xf bank_mask:0xf
    v_mov_b32_dpp v84, v84 quad_perm:[0,0,0,0] row_mask:0xf bank_mask:0xf
    v_add_f32_dpp v72, v73, v72 quad_perm:[1,1,1,1] row_mask:0xf bank_mask:0xf
    v_add_f32_dpp v76, v77, v76 quad_perm:[1,1,1,1] row_mask:0xf bank_mask:0xf
    v_add_f32_dpp v80, v81, v80 quad_perm:[1,1,1,1] row_mask:0xf bank_mask:0xf
    v_add_f32_dpp v84, v85, v84 quad_perm:[1,1,1,1] row_mask:0xf bank_mask:0xf
    v_add_f32_dpp v72, v74, v72 quad_perm:[2,2,2,2] row_mask:0xf bank_mask:0xf
    v_add_f32_dpp v76, v78, v76 quad_perm:[2,2,2,2] row_mask:0xf bank_mask:0xf
    v_add_f32_dpp v80, v82, v80 quad_perm:[2,2,2,2] row_mask:0xf bank_mask:0xf
    v_add_f32_dpp v84, v86, v84 quad_perm:[2,2,2,2] row_mask:0xf bank_mask:0xf
    v_add_f32_dpp v72, v75, v72 quad_perm:[3,3,3,3] row_mask:0xf bank_mask:0xf
    v_add_f32_dpp v76, v79, v76 quad_perm:[3,3,3,3] row_mask:0xf bank_mask:0xf
    v_add_f32_dpp v80, v83, v80 quad_perm:[3,3,3,3] row_mask:0xf bank_mask:0xf
    v_add_f32_dpp v84, v87, v84 quad_perm:[3,3,3,3] row_mask:0xf bank_mask:0xf
    v_cndmask_b32 v30, v40, v44, s[44:45]
    v_cndmask_b32 v31, v72, v76, s[44:45]
    v_cndmask_b32 v30, v30, v48, s[46:47]
    v_cndmask_b32 v31, v31, v80, s[46:47]
    v_cndmask_b32 v30, v30, v52, s[48:49]
    v_cndmask_b32 v31, v31, v84, s[48:49]
    v_cvt_pk_bf16_f32 v32, v30, v31
    v_lshlrev_b32 v30, 16, v32
    v_and_b32 v31, 0xffff0000, v32
    v_pk_mul_f32 v[30:31], v[30:31], s[70:71] op_sel_hi:[1,0]
    v_cvt_pk_bf16_f32 v32, v30, v31
    v_lshlrev_b32 v30, 16, v32
    v_and_b32 v31, 0xffff0000, v32
    v_max_f32 v32, v30, v31
    s_nop 1
    v_max_f32_dpp v32, v32, v32 quad_perm:[1,0,3,2] row_mask:0xf bank_mask:0xf
    s_nop 1
    v_max_f32_dpp v32, v32, v32 quad_perm:[2,3,0,1] row_mask:0xf bank_mask:0xf
    s_nop 1
    v_max_f32_dpp v32, v32, v32 row_half_mirror row_mask:0xf bank_mask:0xf
    v_mov_b32 v33, v32
    s_nop 1
    v_permlane32_swap_b32 v32, v33
    v_max_f32 v32, v32, v33
    v_mov_b32 v33, v32
    s_nop 1
    v_permlane16_swap_b32 v32, v33
    v_max_f32 v32, v32, v33
    v_pk_add_f32 v[30:31], v[30:31], v[32:33] op_sel_hi:[1,0] neg_lo:[0,1] neg_hi:[0,1]
    ds_write_b32 v19, v32 offset:64
    v_pk_mul_f32 v[30:31], v[30:31], s[70:71] op_sel:[0,1] op_sel_hi:[1,1]
    s_nop 0
    v_exp_f32 v30, v30
    v_exp_f32 v31, v31
    s_nop 0
    v_add_f32 v33, v30, v31
    v_cvt_pk_bf16_f32 v30, v30, v30
    v_cvt_pk_bf16_f32 v31, v31, v31
    v_add_f32_dpp v33, v33, v33 quad_perm:[1,0,3,2] row_mask:0xf bank_mask:0xf
    v_mov_b32_dpp v34, v30 row_half_mirror row_mask:0xf bank_mask:0xf
    v_mov_b32_dpp v35, v31 row_half_mirror row_mask:0xf bank_mask:0xf
    v_add_f32_dpp v33, v33, v33 quad_perm:[2,3,0,1] row_mask:0xf bank_mask:0xf
    v_and_b32_dpp v40, v30, v4 quad_perm:[0,0,0,0] row_mask:0xf bank_mask:0xf
    v_and_b32_dpp v41, v30, v5 quad_perm:[0,0,0,0] row_mask:0xf bank_mask:0xf
    v_and_b32_dpp v42, v34, v6 quad_perm:[3,3,3,3] row_mask:0xf bank_mask:0xf
    v_and_b32_dpp v43, v34, v7 quad_perm:[3,3,3,3] row_mask:0xf bank_mask:0xf
    v_add_f32_dpp v33, v33, v33 row_half_mirror row_mask:0xf bank_mask:0xf
    v_and_b32_dpp v44, v30, v4 quad_perm:[1,1,1,1] row_mask:0xf bank_mask:0xf
    v_and_b32_dpp v45, v30, v5 quad_perm:[1,1,1,1] row_mask:0xf bank_mask:0xf
    v_and_b32_dpp v46, v34, v6 quad_perm:[2,2,2,2] row_mask:0xf bank_mask:0xf
    v_and_b32_dpp v47, v34, v7 quad_perm:[2,2,2,2] row_mask:0xf bank_mask:0xf
    v_mov_b32 v36, v33
    s_nop 1
    v_permlane32_swap_b32 v33, v36
    v_add_f32 v33, v33, v36
    v_mov_b32 v36, v33
    s_nop 1
    v_permlane16_swap_b32 v33, v36
    v_add_f32 v33, v33, v36
    ds_write_b32 v19, v33 offset:96
    v_mov_b32 v36, 1
    s_mov_b64 exec, 1
    ds_add_u32 v247, v36 offset:8
    s_mov_b64 exec, -1
    s_setprio 2
    buffer_load_dwordx4 v[180:183], v16, s[52:55], s66 offen nt
    s_add_u32 s66, s66, s64
    buffer_load_dwordx4 v[184:187], v16, s[52:55], s66 offen nt
    s_add_u32 s66, s66, s64
    buffer_load_dwordx4 v[188:191], v16, s[52:55], s66 offen nt
    s_add_u32 s66, s66, s64
    v_and_b32_dpp v48, v30, v4 quad_perm:[2,2,2,2] row_mask:0xf bank_mask:0xf
    v_and_b32_dpp v49, v30, v5 quad_perm:[2,2,2,2] row_mask:0xf bank_mask:0xf
    v_and_b32_dpp v50, v34, v6 quad_perm:[1,1,1,1] row_mask:0xf bank_mask:0xf
    v_and_b32_dpp v51, v34, v7 quad_perm:[1,1,1,1] row_mask:0xf bank_mask:0xf
    s_waitcnt vmcnt(21)
    v_mfma_f32_16x16x32_bf16 v[240:243], v[40:43], v[104:107], 0
    v_and_b32_dpp v52, v30, v4 quad_perm:[3,3,3,3] row_mask:0xf bank_mask:0xf
    v_and_b32_dpp v53, v30, v5 quad_perm:[3,3,3,3] row_mask:0xf bank_mask:0xf
    v_and_b32_dpp v54, v34, v6 quad_perm:[0,0,0,0] row_mask:0xf bank_mask:0xf
    v_and_b32_dpp v55, v34, v7 quad_perm:[0,0,0,0] row_mask:0xf bank_mask:0xf
    s_waitcnt vmcnt(20)
    v_mfma_f32_16x16x32_bf16 v[240:243], v[44:47], v[108:111], v[240:243]
    v_and_b32_dpp v56, v34, v4 quad_perm:[3,3,3,3] row_mask:0xf bank_mask:0xf
    v_and_b32_dpp v57, v34, v5 quad_perm:[3,3,3,3] row_mask:0xf bank_mask:0xf
    v_and_b32_dpp v58, v30, v6 quad_perm:[0,0,0,0] row_mask:0xf bank_mask:0xf
    v_and_b32_dpp v59, v30, v7 quad_perm:[0,0,0,0] row_mask:0xf bank_mask:0xf
    s_waitcnt vmcnt(19)
    v_mfma_f32_16x16x32_bf16 v[240:243], v[48:51], v[112:115], v[240:243]
    v_and_b32_dpp v60, v34, v4 quad_perm:[2,2,2,2] row_mask:0xf bank_mask:0xf
    v_and_b32_dpp v61, v34, v5 quad_perm:[2,2,2,2] row_mask:0xf bank_mask:0xf
    v_and_b32_dpp v62, v30, v6 quad_perm:[1,1,1,1] row_mask:0xf bank_mask:0xf
    v_and_b32_dpp v63, v30, v7 quad_perm:[1,1,1,1] row_mask:0xf bank_mask:0xf
    s_waitcnt vmcnt(18)
    v_mfma_f32_16x16x32_bf16 v[240:243], v[52:55], v[116:119], v[240:243]
    v_and_b32_dpp v64, v34, v4 quad_perm:[1,1,1,1] row_mask:0xf bank_mask:0xf
    v_and_b32_dpp v65, v34, v5 quad_perm:[1,1,1,1] row_mask:0xf bank_mask:0xf
    v_and_b32_dpp v66, v30, v6 quad_perm:[2,2,2,2] row_mask:0xf bank_mask:0xf
    v_and_b32_dpp v67, v30, v7 quad_perm:[2,2,2,2] row_mask:0xf bank_mask:0xf
    s_waitcnt vmcnt(17)
    v_mfma_f32_16x16x32_bf16 v[240:243], v[56:59], v[120:123], v[240:243]
    v_and_b32_dpp v68, v34, v4 quad_perm:[0,0,0,0] row_mask:0xf bank_mask:0xf
    v_and_b32_dpp v69, v34, v5 quad_perm:[0,0,0,0] row_mask:0xf bank_mask:0xf
    v_and_b32_dpp v70, v30, v6 quad_perm:[3,3,3,3] row_mask:0xf bank_mask:0xf
    v_and_b32_dpp v71, v30, v7 quad_perm:[3,3,3,3] row_mask:0xf bank_mask:0xf
    s_waitcnt vmcnt(16)
    v_mfma_f32_16x16x32_bf16 v[240:243], v[60:63], v[124:127], v[240:243]
    v_and_b32_dpp v72, v31, v4 quad_perm:[0,0,0,0] row_mask:0xf bank_mask:0xf
    v_and_b32_dpp v73, v31, v5 quad_perm:[0,0,0,0] row_mask:0xf bank_mask:0xf
    v_and_b32_dpp v74, v35, v6 quad_perm:[3,3,3,3] row_mask:0xf bank_mask:0xf
    v_and_b32_dpp v75, v35, v7 quad_perm:[3,3,3,3] row_mask:0xf bank_mask:0xf
    s_waitcnt vmcnt(15)
    v_mfma_f32_16x16x32_bf16 v[240:243], v[64:67], v[128:131], v[240:243]
    v_and_b32_dpp v76, v31, v4 quad_perm:[1,1,1,1] row_mask:0xf bank_mask:0xf
    v_and_b32_dpp v77, v31, v5 quad_perm:[1,1,1,1] row_mask:0xf bank_mask:0xf
    v_and_b32_dpp v78, v35, v6 quad_perm:[2,2,2,2] row_mask:0xf bank_mask:0xf
    v_and_b32_dpp v79, v35, v7 quad_perm:[2,2,2,2] row_mask:0xf bank_mask:0xf
    s_waitcnt vmcnt(14)
    v_mfma_f32_16x16x32_bf16 v[240:243], v[68:71], v[132:135], v[240:243]
    buffer_load_dwordx4 v[192:195], v16, s[52:55], s66 offen nt
    s_add_u32 s66, s66, s64
    buffer_load_dwordx4 v[196:199], v16, s[52:55], s66 offen nt
    s_add_u32 s66, s66, s64
    v_and_b32_dpp v80, v31, v4 quad_perm:[2,2,2,2] row_mask:0xf bank_mask:0xf
    v_and_b32_dpp v81, v31, v5 quad_perm:[2,2,2,2] row_mask:0xf bank_mask:0xf
    v_and_b32_dpp v82, v35, v6 quad_perm:[1,1,1,1] row_mask:0xf bank_mask:0xf
    v_and_b32_dpp v83, v35, v7 quad_perm:[1,1,1,1] row_mask:0xf bank_mask:0xf
    v_and_b32_dpp v84, v31, v4 quad_perm:[3,3,3,3] row_mask:0xf bank_mask:0xf
    v_and_b32_dpp v85, v31, v5 quad_perm:[3,3,3,3] row_mask:0xf bank_mask:0xf
    v_and_b32_dpp v86, v35, v6 quad_perm:[0,0,0,0] row_mask:0xf bank_mask:0xf
    v_and_b32_dpp v87, v35, v7 quad_perm:[0,0,0,0] row_mask:0xf bank_mask:0xf
    v_and_b32_dpp v88, v35, v4 quad_perm:[3,3,3,3] row_mask:0xf bank_mask:0xf
    v_and_b32_dpp v89, v35, v5 quad_perm:[3,3,3,3] row_mask:0xf bank_mask:0xf
    v_and_b32_dpp v90, v31, v6 quad_perm:[0,0,0,0] row_mask:0xf bank_mask:0xf
    v_and_b32_dpp v91, v31, v7 quad_perm:[0,0,0,0] row_mask:0xf bank_mask:0xf
    v_and_b32_dpp v92, v35, v4 quad_perm:[2,2,2,2] row_mask:0xf bank_mask:0xf
    v_and_b32_dpp v93, v35, v5 quad_perm:[2,2,2,2] row_mask:0xf bank_mask:0xf
    v_and_b32_dpp v94, v31, v6 quad_perm:[1,1,1,1] row_mask:0xf bank_mask:0xf
    v_and_b32_dpp v95, v31, v7 quad_perm:[1,1,1,1] row_mask:0xf bank_mask:0xf
    v_and_b32_dpp v96, v35, v4 quad_perm:[1,1,1,1] row_mask:0xf bank_mask:0xf
    v_and_b32_dpp v97, v35, v5 quad_perm:[1,1,1,1] row_mask:0xf bank_mask:0xf
    v_and_b32_dpp v98, v31, v6 quad_perm:[2,2,2,2] row_mask:0xf bank_mask:0xf
    v_and_b32_dpp v99, v31, v7 quad_perm:[2,2,2,2] row_mask:0xf bank_mask:0xf
    v_and_b32_dpp v100, v35, v4 quad_perm:[0,0,0,0] row_mask:0xf bank_mask:0xf
    v_and_b32_dpp v101, v35, v5 quad_perm:[0,0,0,0] row_mask:0xf bank_mask:0xf
    v_and_b32_dpp v102, v31, v6 quad_perm:[3,3,3,3] row_mask:0xf bank_mask:0xf
    v_and_b32_dpp v103, v31, v7 quad_perm:[3,3,3,3] row_mask:0xf bank_mask:0xf
    s_lshl_b32 s70, s96, 2
    v_add_u32 v3, s70, v17
    s_mov_b32 s68, 800000
lw_7:
    ds_read_b32 v36, v247 offset:8
    s_waitcnt lgkmcnt(0)
    v_cmp_le_u32 vcc, 4, v36
    s_cbranch_vccnz lwd_8
    s_sleep 1
    s_sub_u32 s68, s68, 1
    s_cbranch_scc0 lw_7
lwd_8:
    ds_read_b128 v[20:23], v17 offset:64
    ds_read_b128 v[24:27], v17 offset:96
    ds_read_b32 v36, v3 offset:64
    ds_read_b32 v37, v247 offset:28
    s_lshl_b32 s70, s96, 10
    s_waitcnt lgkmcnt(0)
    v_readfirstlane_b32 s27, v37
    v_max3_f32 v32, v20, v21, v22
    v_max_f32 v32, v32, v23
    v_sub_f32 v20, v20, v32
    v_sub_f32 v21, v21, v32
    v_sub_f32 v22, v22, v32
    v_sub_f32 v23, v23, v32
    v_sub_f32 v36, v36, v32
    v_mul_f32 v20, s71, v20
    v_mul_f32 v21, s71, v21
    v_mul_f32 v22, s71, v22
    v_mul_f32 v23, s71, v23
    v_mul_f32 v36, s71, v36
    v_exp_f32 v20, v20
    v_exp_f32 v21, v21
    v_exp_f32 v22, v22
    v_exp_f32 v23, v23
    v_exp_f32 v36, v36
    v_mul_f32 v33, v20, v24
    v_fmac_f32 v33, v21, v25
    v_fmac_f32 v33, v22, v26
    v_fmac_f32 v33, v23, v27
    v_permlane32_swap_b32 v32, v34
    s_nop 0
    v_permlane32_swap_b32 v33, v35
    v_perm_b32 v32, v32, v12, s12
    v_perm_b32 v33, v33, v12, s13
    v_perm_b32 v34, v34, v12, s14
    v_perm_b32 v35, v35, v12, s15
    v_lshlrev_b32 v20, 4, v0
    v_add_u32 v19, s70, v20
    s_waitcnt vmcnt(15)
    v_mfma_f32_16x16x32_bf16 v[240:243], v[72:75], v[136:139], v[240:243]
    s_waitcnt vmcnt(14)
    v_mfma_f32_16x16x32_bf16 v[240:243], v[76:79], v[140:143], v[240:243]
    s_waitcnt vmcnt(13)
    v_mfma_f32_16x16x32_bf16 v[240:243], v[80:83], v[144:147], v[240:243]
    s_waitcnt vmcnt(12)
    v_mfma_f32_16x16x32_bf16 v[240:243], v[84:87], v[148:151], v[240:243]
    s_waitcnt vmcnt(11)
    v_mfma_f32_16x16x32_bf16 v[240:243], v[88:91], v[152:155], v[240:243]
    s_waitcnt vmcnt(10)
    v_mfma_f32_16x16x32_bf16 v[240:243], v[92:95], v[156:159], v[240:243]
    s_waitcnt vmcnt(9)
    v_mfma_f32_16x16x32_bf16 v[240:243], v[96:99], v[160:163], v[240:243]
    s_waitcnt vmcnt(8)
    v_mfma_f32_16x16x32_bf16 v[240:243], v[100:103], v[164:167], v[240:243]
    s_nop 7
    v_pk_mul_f32 v[240:241], v[240:241], v[36:37] op_sel_hi:[1,0]
    v_pk_mul_f32 v[242:243], v[242:243], v[36:37] op_sel_hi:[1,0]
    ds_write_b128 v19, v[240:243] offset:1024
    v_mov_b32 v26, 1
    s_mov_b64 exec, 1
    ds_add_rtn_u32 v26, v247, v26 offset:12
    s_mov_b64 exec, -1
    ds_read_b128 v[40:43], v20 offset:1024
    ds_read_b128 v[44:47], v20 offset:2048
    ds_read_b128 v[48:51], v20 offset:3072
    ds_read_b128 v[52:55], v20 offset:4096
    s_waitcnt lgkmcnt(4)
    v_readfirstlane_b32 s69, v26
    s_cmp_lg_u32 s69, 3
    s_waitcnt lgkmcnt(0)
    s_cbranch_scc1 L_m_pub_done
    v_pk_add_f32 v[40:41], v[40:41], v[44:45]
    v_pk_add_f32 v[42:43], v[42:43], v[46:47]
    v_pk_add_f32 v[48:49], v[48:49], v[52:53]
    v_pk_add_f32 v[50:51], v[50:51], v[54:55]
    v_pk_add_f32 v[40:41], v[40:41], v[48:49]
    v_pk_add_f32 v[42:43], v[42:43], v[50:51]
    v_perm_b32 v40, v40, v244, s12
    s_cmp_eq_u32 s27, 2
    s_cbranch_scc0 ps_9
    buffer_store_dwordx4 v[40:43], v18, s[60:63], s97 offen
pe_10:
    s_mov_b64 exec, 1
    s_cmp_eq_u32 s27, 2
    s_cbranch_scc0 ps_11
    buffer_store_dwordx4 v[32:35], v247, s[60:63], s97 offen offset:1024
pe_12:
    s_mov_b64 exec, -1
    v_mov_b32 v26, 1
    s_mov_b64 exec, 1
    ds_add_u32 v247, v26 offset:32
    s_mov_b64 exec, -1
L_m_pub_done:
    s_cmp_lg_u32 s6, 0
    s_cbranch_scc1 L_m_other
    v_mul_u32_u24 v3, 1152, v1
    v_and_b32 v21, 3, v2
    v_mul_u32_u24 v21, 4608, v21
    v_add_u32 v21, v21, v3
    s_mul_i32 s70, s4, 18432
    s_add_u32 s48, s70, 524288
    v_lshl_add_u32 v3, v2, 4, v3
    s_lshl_b32 s71, s96, 8
    s_add_u32 s44, s48, s71
    s_add_u32 s45, s44, 4608
    s_add_u32 s46, s44, 9216
    s_add_u32 s47, s44, 13824
    s_mul_i32 s97, s4, 2304
    s_lshl_b32 s70, s5, 8
    s_add_u32 s97, s97, s70
    s_add_u32 s97, s97, 53248
    s_and_b32 s70, s4, 7
    s_mul_i32 s70, s70, 18
    s_lshr_b32 s71, s4, 3
    s_mul_i32 s71, s71, 9
    s_add_u32 s70, s70, s71
    s_add_u32 s70, s70, s5
    s_mul_i32 s69, s70, 36864
    s_add_u32 s56, s32, s69
    s_addc_u32 s57, s33, 0
    s_mov_b32 s58, 36864
    s_mov_b32 s59, 0x20000
    s_mov_b32 s67, 0
    s_mul_i32 s70, s96, 72
    v_add_lshl_u32 v23, v0, s70, 7
    s_mov_b32 s67, 8192
    s_cmp_ge_u32 s96, 2
    s_cselect_b64 s[70:71], -1, 0
    s_mov_b32 s49, 20000
L_s3poll:
    s_mov_b32 s68, 20000
    buffer_load_dwordx4 v[120:123], v21, s[60:63], s48 offen offset:1024 sc1
poll_13:
    s_waitcnt vmcnt(0)
    v_xor_b32 v22, s8, v120
    v_bitop3_b32 v22, v121, s9, v22 bitop3:0xbe
    v_bitop3_b32 v22, v122, s10, v22 bitop3:0xbe
    v_bitop3_b32 v22, v123, s11, v22 bitop3:0xbe
    v_and_b32 v22, 0xff, v22
    v_cmp_ne_u32 vcc, 0, v22
    s_cbranch_vccz ok_15
    s_sub_u32 s68, s68, 1
    s_cbranch_scc1 ok_15
    buffer_load_dwordx4 v[120:123], v21, s[60:63], s48 offen offset:1024 sc1
    s_branch poll_13
ok_15:
pd_14:
    buffer_load_dwordx4 v[104:107], v3, s[60:63], s44 offen sc1
    buffer_load_dwordx4 v[108:111], v3, s[60:63], s45 offen sc1
    buffer_load_dwordx4 v[112:115], v3, s[60:63], s46 offen sc1
    buffer_load_dwordx4 v[116:119], v3, s[60:63], s47 offen sc1
    v_cndmask_b32 v24, v120, v122, s[70:71]
    v_cndmask_b32 v25, v121, v123, s[70:71]
    v_and_b32 v24, 0xffff0000, v24
    s_nop 1
    v_max_f32_dpp v26, v24, v24 quad_perm:[1,0,3,2] row_mask:0xf bank_mask:0xf
    s_nop 1
    v_max_f32_dpp v26, v26, v26 quad_perm:[2,3,0,1] row_mask:0xf bank_mask:0xf
    v_mov_b32 v27, v26
    s_nop 1
    v_permlane32_swap_b32 v26, v27
    v_max_f32 v26, v26, v27
    v_mov_b32 v27, v26
    s_nop 1
    v_permlane16_swap_b32 v26, v27
    v_max_f32 v26, v26, v27
    v_sub_f32 v24, v24, v26
    v_mul_f32 v24, 0x3fb8aa3b, v24
    v_exp_f32 v24, v24
    s_nop 0
    v_mul_f32 v25, v24, v25
    s_nop 1
    v_add_f32_dpp v25, v25, v25 quad_perm:[1,0,3,2] row_mask:0xf bank_mask:0xf
    s_nop 1
    v_add_f32_dpp v25, v25, v25 quad_perm:[2,3,0,1] row_mask:0xf bank_mask:0xf
    v_mov_b32 v27, v25
    s_nop 1
    v_permlane32_swap_b32 v25, v27
    v_add_f32 v25, v25, v27
    v_mov_b32 v27, v25
    s_nop 1
    v_permlane16_swap_b32 v25, v27
    v_add_f32 v25, v25, v27
    v_rcp_f32 v25, v25
    s_nop 0
    v_mul_f32 v24, v24, v25
    s_waitcnt vmcnt(3)
    v_xor_b32 v22, v245, v104
    v_mul_f32_dpp v28, v24, v104 quad_perm:[0,0,0,0] row_mask:0xf bank_mask:0xf
    v_mul_f32_dpp v29, v24, v105 quad_perm:[0,0,0,0] row_mask:0xf bank_mask:0xf
    v_mul_f32_dpp v30, v24, v106 quad_perm:[0,0,0,0] row_mask:0xf bank_mask:0xf
    v_mul_f32_dpp v31, v24, v107 quad_perm:[0,0,0,0] row_mask:0xf bank_mask:0xf
    s_waitcnt vmcnt(2)
    v_bitop3_b32 v22, v108, v245, v22 bitop3:0xbe
    v_fmac_f32_dpp v28, v24, v108 quad_perm:[1,1,1,1] row_mask:0xf bank_mask:0xf
    v_fmac_f32_dpp v29, v24, v109 quad_perm:[1,1,1,1] row_mask:0xf bank_mask:0xf
    v_fmac_f32_dpp v30, v24, v110 quad_perm:[1,1,1,1] row_mask:0xf bank_mask:0xf
    v_fmac_f32_dpp v31, v24, v111 quad_perm:[1,1,1,1] row_mask:0xf bank_mask:0xf
    s_waitcnt vmcnt(1)
    v_bitop3_b32 v22, v112, v245, v22 bitop3:0xbe
    v_fmac_f32_dpp v28, v24, v112 quad_perm:[2,2,2,2] row_mask:0xf bank_mask:0xf
    v_fmac_f32_dpp v29, v24, v113 quad_perm:[2,2,2,2] row_mask:0xf bank_mask:0xf
    v_fmac_f32_dpp v30, v24, v114 quad_perm:[2,2,2,2] row_mask:0xf bank_mask:0xf
    v_fmac_f32_dpp v31, v24, v115 quad_perm:[2,2,2,2] row_mask:0xf bank_mask:0xf
    s_waitcnt vmcnt(0)
    v_bitop3_b32 v22, v116, v245, v22 bitop3:0xbe
    v_fmac_f32_dpp v28, v24, v116 quad_perm:[3,3,3,3] row_mask:0xf bank_mask:0xf
    v_fmac_f32_dpp v29, v24, v117 quad_perm:[3,3,3,3] row_mask:0xf bank_mask:0xf
    v_fmac_f32_dpp v30, v24, v118 quad_perm:[3,3,3,3] row_mask:0xf bank_mask:0xf
    v_fmac_f32_dpp v31, v24, v119 quad_perm:[3,3,3,3] row_mask:0xf bank_mask:0xf
    v_and_b32 v22, 0xff, v22
    v_cmp_ne_u32 vcc, 0, v22
    s_cbranch_vccnz L_s3retry
L_s3ok:
    v_permlane32_swap_b32 v28, v30
    v_permlane32_swap_b32 v29, v31
    v_pk_add_f32 v[28:29], v[28:29], v[30:31]
    s_nop 1
    v_permlane16_swap_b32 v28, v29
    v_add_f32 v28, v28, v29
    v_cvt_pk_bf16_f32 v28, v28, v28
    s_nop 1
    v_mov_b32_dpp v29, v28 row_half_mirror row_mask:0xf bank_mask:0xf
    v_and_b32_dpp v40, v28, v4 quad_perm:[0,0,0,0] row_mask:0xf bank_mask:0xf
    v_and_b32_dpp v41, v28, v5 quad_perm:[0,0,0,0] row_mask:0xf bank_mask:0xf
    v_and_b32_dpp v42, v29, v6 quad_perm:[3,3,3,3] row_mask:0xf bank_mask:0xf
    v_and_b32_dpp v43, v29, v7 quad_perm:[3,3,3,3] row_mask:0xf bank_mask:0xf
    v_and_b32_dpp v44, v28, v4 quad_perm:[1,1,1,1] row_mask:0xf bank_mask:0xf
    v_and_b32_dpp v45, v28, v5 quad_perm:[1,1,1,1] row_mask:0xf bank_mask:0xf
    v_and_b32_dpp v46, v29, v6 quad_perm:[2,2,2,2] row_mask:0xf bank_mask:0xf
    v_and_b32_dpp v47, v29, v7 quad_perm:[2,2,2,2] row_mask:0xf bank_mask:0xf
    v_mfma_f32_16x16x32_bf16 v[240:243], v[40:43], v[168:171], 0
    v_and_b32_dpp v48, v28, v4 quad_perm:[2,2,2,2] row_mask:0xf bank_mask:0xf
    v_and_b32_dpp v49, v28, v5 quad_perm:[2,2,2,2] row_mask:0xf bank_mask:0xf
    v_and_b32_dpp v50, v29, v6 quad_perm:[1,1,1,1] row_mask:0xf bank_mask:0xf
    v_and_b32_dpp v51, v29, v7 quad_perm:[1,1,1,1] row_mask:0xf bank_mask:0xf
    v_mfma_f32_16x16x32_bf16 v[240:243], v[44:47], v[172:175], v[240:243]
    v_and_b32_dpp v40, v28, v4 quad_perm:[3,3,3,3] row_mask:0xf bank_mask:0xf
    v_and_b32_dpp v41, v28, v5 quad_perm:[3,3,3,3] row_mask:0xf bank_mask:0xf
    v_and_b32_dpp v42, v29, v6 quad_perm:[0,0,0,0] row_mask:0xf bank_mask:0xf
    v_and_b32_dpp v43, v29, v7 quad_perm:[0,0,0,0] row_mask:0xf bank_mask:0xf
    v_mfma_f32_16x16x32_bf16 v[240:243], v[48:51], v[176:179], v[240:243]
    v_and_b32_dpp v44, v29, v4 quad_perm:[3,3,3,3] row_mask:0xf bank_mask:0xf
    v_and_b32_dpp v45, v29, v5 quad_perm:[3,3,3,3] row_mask:0xf bank_mask:0xf
    v_and_b32_dpp v46, v28, v6 quad_perm:[0,0,0,0] row_mask:0xf bank_mask:0xf
    v_and_b32_dpp v47, v28, v7 quad_perm:[0,0,0,0] row_mask:0xf bank_mask:0xf
    v_mfma_f32_16x16x32_bf16 v[240:243], v[40:43], v[180:183], v[240:243]
    v_and_b32_dpp v48, v29, v4 quad_perm:[2,2,2,2] row_mask:0xf bank_mask:0xf
    v_and_b32_dpp v49, v29, v5 quad_perm:[2,2,2,2] row_mask:0xf bank_mask:0xf
    v_and_b32_dpp v50, v28, v6 quad_perm:[1,1,1,1] row_mask:0xf bank_mask:0xf
    v_and_b32_dpp v51, v28, v7 quad_perm:[1,1,1,1] row_mask:0xf bank_mask:0xf
    v_mfma_f32_16x16x32_bf16 v[240:243], v[44:47], v[184:187], v[240:243]
    v_and_b32_dpp v40, v29, v4 quad_perm:[1,1,1,1] row_mask:0xf bank_mask:0xf
    v_and_b32_dpp v41, v29, v5 quad_perm:[1,1,1,1] row_mask:0xf bank_mask:0xf
    v_and_b32_dpp v42, v28, v6 quad_perm:[2,2,2,2] row_mask:0xf bank_mask:0xf
    v_and_b32_dpp v43, v28, v7 quad_perm:[2,2,2,2] row_mask:0xf bank_mask:0xf
    v_mfma_f32_16x16x32_bf16 v[240:243], v[48:51], v[188:191], v[240:243]
    v_and_b32_dpp v44, v29, v4 quad_perm:[0,0,0,0] row_mask:0xf bank_mask:0xf
    v_and_b32_dpp v45, v29, v5 quad_perm:[0,0,0,0] row_mask:0xf bank_mask:0xf
    v_and_b32_dpp v46, v28, v6 quad_perm:[3,3,3,3] row_mask:0xf bank_mask:0xf
    v_and_b32_dpp v47, v28, v7 quad_perm:[3,3,3,3] row_mask:0xf bank_mask:0xf
    v_mfma_f32_16x16x32_bf16 v[240:243], v[40:43], v[192:195], v[240:243]
    s_nop 0
    v_mfma_f32_16x16x32_bf16 v[240:243], v[44:47], v[196:199], v[240:243]
L_comb:
    s_nop 7
    ds_write_b128 v19, v[240:243] offset:5120
    v_mov_b32 v26, 1
    s_mov_b64 exec, 1
    ds_add_rtn_u32 v26, v247, v26 offset:16
    s_mov_b64 exec, -1
    ds_read_b128 v[40:43], v20 offset:5120
    ds_read_b128 v[44:47], v20 offset:6144
    ds_read_b128 v[48:51], v20 offset:7168
    ds_read_b128 v[52:55], v20 offset:8192
    s_waitcnt lgkmcnt(4)
    v_readfirstlane_b32 s69, v26
    s_cmp_lg_u32 s69, 3
    s_waitcnt lgkmcnt(0)
    s_cbranch_scc1 L_w_pf
    v_pk_add_f32 v[40:41], v[40:41], v[44:45]
    v_pk_add_f32 v[42:43], v[42:43], v[46:47]
    v_pk_add_f32 v[48:49], v[48:49], v[52:53]
    v_pk_add_f32 v[50:51], v[50:51], v[54:55]
    v_pk_add_f32 v[40:41], v[40:41], v[48:49]
    v_pk_add_f32 v[42:43], v[42:43], v[50:51]
    s_nop 0
    v_permlane32_swap_b32 v40, v44
    v_permlane32_swap_b32 v41, v45
    v_permlane32_swap_b32 v42, v46
    v_permlane32_swap_b32 v43, v47
    v_add_f32_dpp v40, v44, v40 row_ror:8 row_mask:0xf bank_mask:0xf
    v_add_f32_dpp v41, v45, v41 row_ror:8 row_mask:0xf bank_mask:0xf
    v_add_f32_dpp v42, v46, v42 row_ror:8 row_mask:0xf bank_mask:0xf
    v_add_f32_dpp v43, v47, v43 row_ror:8 row_mask:0xf bank_mask:0xf
    v_perm_b32 v40, v40, v244, s12
    s_mov_b64 exec, 0x00ff00ff
    buffer_store_dwordx4 v[40:43], v246, s[60:63], s97 offen sc1
    s_mov_b64 exec, 1
    v_mov_b32 v32, s8
    v_mov_b32 v33, s9
    v_mov_b32 v34, s10
    v_mov_b32 v35, s11
    s_lshl_b32 s70, s4, 4
    s_add_u32 s70, s70, s5
    s_mul_i32 s70, s70, 1152
    s_add_u32 s70, s70, 524288
    s_cmp_eq_u32 s27, 2
    s_cbranch_scc0 ps_16
    buffer_store_dwordx4 v[32:35], v247, s[60:63], s70 offen offset:1040
pe_17:
    s_mov_b64 exec, -1
    v_mov_b32 v26, 1
    s_mov_b64 exec, 1
    ds_add_u32 v247, v26 offset:40
    s_mov_b64 exec, -1
L_w_pf:
    s_mov_b32 s68, 800000
lw_18:
    ds_read_b32 v26, v247 offset:40
    s_waitcnt lgkmcnt(0)
    v_cmp_le_u32 vcc, 1, v26
    s_cbranch_vccnz lwd_19
    s_sleep 1
    s_sub_u32 s68, s68, 1
    s_cbranch_scc0 lw_18
lwd_19:
    buffer_load_dword v200, v23, s[56:59], 0 offen
    s_mov_b64 exec, 0xff
    buffer_load_dword v201, v23, s[56:59], s67 offen
    s_mov_b64 exec, -1
    s_endpgm
L_m_end:
    s_endpgm
L_m_other:
    s_setprio 0
    s_cmp_eq_u32 s6, 1
    s_cbranch_scc1 L_m_m
    s_branch L_m_end
L_c_post:
    v_mov_b32 v16, 0
    s_sub_u32 s69, s2, 216
    s_cmp_ge_u32 s69, 36
    s_cselect_b32 s6, 3, 2
    s_and_b32 s70, s4, 7
    s_lshr_b32 s71, s4, 3
    s_mul_i32 s7, s70, 9
    s_add_u32 s7, s7, s71
    s_cmp_eq_u32 s5, 13
    s_cselect_b32 s69, s70, s69
    s_cselect_b32 s6, 2, s6
    s_lshl_b32 s70, s5, 1
    s_add_u32 s7, s7, s70
    s_sub_u32 s7, s7, 18
    s_cmp_lt_u32 s2, 216
    s_cselect_b32 s7, s7, s69
    s_cselect_b32 s6, 1, s6
    s_cmp_lt_u32 s5, 9
    s_cselect_b32 s7, s5, s7
    s_cselect_b32 s6, 0, s6
    v_and_b32 v3, 1, v2
    v_lshlrev_b32 v3, 4, v3
    v_mov_b32 v8, 0xffff
    v_lshlrev_b32 v3, v3, v8
    v_bfe_u32 v8, v2, 1, 2
    v_cmp_eq_u32 vcc, 0, v8
    s_nop 1
    v_cndmask_b32 v4, 0, v3, vcc
    v_cmp_eq_u32 vcc, 1, v8
    s_nop 1
    v_cndmask_b32 v5, 0, v3, vcc
    v_cmp_eq_u32 vcc, 2, v8
    s_nop 1
    v_cndmask_b32 v6, 0, v3, vcc
    v_cmp_eq_u32 vcc, 3, v8
    s_nop 1
    v_cndmask_b32 v7, 0, v3, vcc
    v_lshrrev_b32 v3, 3, v2
    s_mov_b32 s69, 0x02020202
    v_mul_lo_u32 v3, v3, s69
    v_add_u32 v3, 0x01000100, v3
    s_mov_b32 s69, 0x0c0c0c0c
    v_bfi_b32 v8, v4, v3, s69
    v_bfi_b32 v9, v5, v3, s69
    v_bfi_b32 v10, v6, v3, s69
    v_bfi_b32 v11, v7, v3, s69
    v_lshlrev_b32 v246, 5, v2
    v_lshl_add_u32 v246, v1, 4, v246
    s_cmp_eq_u32 s3, 3
    s_cbranch_scc0 L_c_n3
    s_lshl_b32 s69, s4, 4
    s_add_u32 s69, s69, s5
    v_lshlrev_b32 v3, 7, v0
    s_lshl_b32 s70, s69, 10
    s_add_u32 s70, s70, 262144
    s_cmp_eq_u32 s6, 0
    s_cselect_b32 exec_lo, 0xff, 1
    s_mov_b32 exec_hi, 0
    buffer_load_dword v234, v3, s[60:63], s70 offen
    s_mov_b64 exec, -1
    s_waitcnt lgkmcnt(0)
    s_mul_i32 s69, s8, 0x9E3779B1
    s_add_u32 s69, s69, 0x7F4A7C15
    s_or_b32 s69, s69, 0x01010101
    s_xor_b32 s8, s8, s69
    s_lshr_b32 s9, s8, 8
    s_lshr_b32 s10, s8, 16
    s_lshr_b32 s11, s8, 24
    s_mov_b32 s12, 0x7060500
    s_mov_b32 s13, 0x7060501
    s_mov_b32 s14, 0x7060502
    s_mov_b32 s15, 0x7060503
    v_mov_b32 v12, s8
    v_lshlrev_b32 v13, 3, v1
    v_lshrrev_b32 v13, v13, v12
    v_and_b32 v245, 1, v1
    v_lshl_add_u32 v244, v2, 1, v245
    v_lshlrev_b32 v244, 3, v244
    v_lshrrev_b32 v244, v244, v12
    v_lshlrev_b32 v245, 3, v2
    v_lshrrev_b32 v245, v245, v12
    s_getreg_b32 s26, hwreg(HW_REG_XCC_ID)
    s_and_b32 s26, s26, 15
    s_and_b32 s70, s8, 0xfffffff0
    s_or_b32 s26, s26, s70
    v_mov_b32 v21, s26
    s_lshl_b32 s70, s4, 11
    s_lshl_b32 s71, s5, 2
    s_add_u32 s70, s70, s71
    s_add_u32 s70, s70, 860160
    v_lshlrev_b32 v3, 7, v0
    s_mov_b64 exec, 0xffff
    buffer_store_dword v21, v3, s[60:63], s70 offen sc1
    s_mov_b64 exec, -1
    s_cmp_lg_u32 s6, 0
    s_cbranch_scc1 L_c_nw3
    s_mul_i32 s64, s4, 18
    s_add_u32 s64, s64, s5
    s_lshl_b32 s64, s64, 7
    s_add_u32 s64, s64, 819200
    s_add_u32 s65, s64, 1152
    s_and_b32 s70, s8, 0xffff
    s_mul_i32 s70, s70, 0x10001
    s_mov_b32 s71, s70
    s_mov_b32 s68, 20000
L_hw:
    s_load_dwordx4 s[44:47], s[42:43], s64 glc
    s_load_dwordx4 s[48:51], s[42:43], s65 glc
    s_waitcnt lgkmcnt(0)
    s_cmp_eq_u64 s[44:45], s[70:71]
    s_cbranch_scc0 L_hf
    s_cmp_eq_u64 s[46:47], s[70:71]
    s_cbranch_scc0 L_hf
    s_cmp_eq_u64 s[48:49], s[70:71]
    s_cbranch_scc0 L_hf
    s_cmp_eq_u64 s[50:51], s[70:71]
    s_cbranch_scc1 L_hd
L_hf:
    s_sleep 1
    s_sub_u32 s68, s68, 1
    s_cbranch_scc0 L_hw
L_hd:
    v_mov_b32 v21, 1
    s_mov_b64 exec, 1
    ds_add_u32 v247, v21 offset:24
    s_mov_b64 exec, -1
L_c3_id:
    s_lshl_b32 s64, s4, 4
    s_add_u32 s64, s64, s5
    s_lshl_b32 s64, s64, 7
    s_add_u32 s64, s64, 860160
    s_mov_b32 s68, 20000
L_iw:
    s_load_dwordx16 s[44:59], s[42:43], s64 glc
    s_mov_b32 s27, 2
    s_waitcnt lgkmcnt(0)
    s_xor_b32 s65, s44, s26
    s_cselect_b32 s27, 1, s27
    s_cmp_ge_u32 s65, 16
    s_cbranch_scc1 L_if
    s_xor_b32 s65, s45, s26
    s_cselect_b32 s27, 1, s27
    s_cmp_ge_u32 s65, 16
    s_cbranch_scc1 L_if
    s_xor_b32 s65, s46, s26
    s_cselect_b32 s27, 1, s27
    s_cmp_ge_u32 s65, 16
    s_cbranch_scc1 L_if
    s_xor_b32 s65, s47, s26
    s_cselect_b32 s27, 1, s27
    s_cmp_ge_u32 s65, 16
    s_cbranch_scc1 L_if
    s_xor_b32 s65, s48, s26
    s_cselect_b32 s27, 1, s27
    s_cmp_ge_u32 s65, 16
    s_cbranch_scc1 L_if
    s_xor_b32 s65, s49, s26
    s_cselect_b32 s27, 1, s27
    s_cmp_ge_u32 s65, 16
    s_cbranch_scc1 L_if
    s_xor_b32 s65, s50, s26
    s_cselect_b32 s27, 1, s27
    s_cmp_ge_u32 s65, 16
    s_cbranch_scc1 L_if
    s_xor_b32 s65, s51, s26
    s_cselect_b32 s27, 1, s27
    s_cmp_ge_u32 s65, 16
    s_cbranch_scc1 L_if
    s_xor_b32 s65, s52, s26
    s_cselect_b32 s27, 1, s27
    s_cmp_ge_u32 s65, 16
    s_cbranch_scc1 L_if
    s_xor_b32 s65, s53, s26
    s_cselect_b32 s27, 1, s27
    s_cmp_ge_u32 s65, 16
    s_cbranch_scc1 L_if
    s_xor_b32 s65, s54, s26
    s_cselect_b32 s27, 1, s27
    s_cmp_ge_u32 s65, 16
    s_cbranch_scc1 L_if
    s_xor_b32 s65, s55, s26
    s_cselect_b32 s27, 1, s27
    s_cmp_ge_u32 s65, 16
    s_cbranch_scc1 L_if
    s_xor_b32 s65, s56, s26
    s_cselect_b32 s27, 1, s27
    s_cmp_ge_u32 s65, 16
    s_cbranch_scc1 L_if
    s_xor_b32 s65, s57, s26
    s_cselect_b32 s27, 1, s27
    s_cmp_ge_u32 s65, 16
    s_cbranch_scc1 L_if
    s_xor_b32 s65, s58, s26
    s_cselect_b32 s27, 1, s27
    s_cmp_ge_u32 s65, 16
    s_cbranch_scc1 L_if
    s_xor_b32 s65, s59, s26
    s_cselect_b32 s27, 1, s27
    s_cmp_ge_u32 s65, 16
    s_cbranch_scc1 L_if
L_id:
    v_mov_b32 v21, s27
    s_mov_b64 exec, 1
    ds_add_u32 v247, v21 offset:28
    s_mov_b64 exec, -1
    s_branch L_c_s2w
L_c_n3:
    s_cmp_lg_u32 s6, 0
    s_cbranch_scc1 L_c_nw
    s_cmp_lg_u32 s3, 0
    s_cbranch_scc1 L_c_wq
    s_and_b32 s70, s4, 7
    s_lshr_b32 s71, s4, 3
    s_mul_i32 s71, s71, 9
    s_add_u32 s71, s71, s5
    s_lshl_b32 s64, s71, 7
    s_lshl_b32 s65, s70, 1
    s_add_u32 s64, s64, s65
    s_add_u32 s64, s64, 819200
    s_mul_i32 s70, s70, 4608
    s_lshl_b32 s71, s71, 8
    s_add_u32 s70, s70, s71
    s_add_u32 s97, s70, 4096
    v_mul_u32_u24 v15, 2304, v0
    s_waitcnt vmcnt(9)
    v_mul_f32 v22, 0xbfb8aa3b, v20
    v_mul_f32 v23, 0xbfb8aa3b, v21
    v_exp_f32 v22, v22
    v_exp_f32 v23, v23
    v_add_f32 v22, 1.0, v22
    v_add_f32 v23, 1.0, v23
    v_rcp_f32 v22, v22
    v_rcp_f32 v23, v23
    v_mul_f32 v20, v20, v22
    v_mul_f32 v21, v21, v23
    v_cvt_pk_bf16_f32 v20, v20, v21
    s_nop 1
    v_mov_b32_dpp v22, v20 row_newbcast:0 row_mask:0xf bank_mask:0xf
    v_perm_b32 v104, v22, v22, v8
    v_perm_b32 v105, v22, v22, v9
    v_perm_b32 v106, v22, v22, v10
    v_perm_b32 v107, v22, v22, v11
    v_mov_b32_dpp v23, v20 row_newbcast:1 row_mask:0xf bank_mask:0xf
    v_perm_b32 v108, v23, v23, v8
    v_perm_b32 v109, v23, v23, v9
    v_perm_b32 v110, v23, v23, v10
    v_perm_b32 v111, v23, v23, v11
    v_mov_b32_dpp v22, v20 row_newbcast:2 row_mask:0xf bank_mask:0xf
    v_perm_b32 v112, v22, v22, v8
    v_perm_b32 v113, v22, v22, v9
    v_perm_b32 v114, v22, v22, v10
    v_perm_b32 v115, v22, v22, v11
    v_mov_b32_dpp v23, v20 row_newbcast:3 row_mask:0xf bank_mask:0xf
    v_perm_b32 v116, v23, v23, v8
    v_perm_b32 v117, v23, v23, v9
    v_perm_b32 v118, v23, v23, v10
    v_perm_b32 v119, v23, v23, v11
    v_mov_b32_dpp v22, v20 row_newbcast:4 row_mask:0xf bank_mask:0xf
    v_perm_b32 v120, v22, v22, v8
    v_perm_b32 v121, v22, v22, v9
    v_perm_b32 v122, v22, v22, v10
    v_perm_b32 v123, v22, v22, v11
    v_mov_b32_dpp v23, v20 row_newbcast:5 row_mask:0xf bank_mask:0xf
    v_perm_b32 v124, v23, v23, v8
    v_perm_b32 v125, v23, v23, v9
    v_perm_b32 v126, v23, v23, v10
    v_perm_b32 v127, v23, v23, v11
    v_mov_b32_dpp v22, v20 row_newbcast:6 row_mask:0xf bank_mask:0xf
    v_perm_b32 v128, v22, v22, v8
    v_perm_b32 v129, v22, v22, v9
    v_perm_b32 v130, v22, v22, v10
    v_perm_b32 v131, v22, v22, v11
    v_mov_b32_dpp v23, v20 row_newbcast:7 row_mask:0xf bank_mask:0xf
    v_perm_b32 v132, v23, v23, v8
    v_perm_b32 v133, v23, v23, v9
    v_perm_b32 v134, v23, v23, v10
    v_perm_b32 v135, v23, v23, v11
    v_mov_b32_dpp v22, v20 row_newbcast:8 row_mask:0xf bank_mask:0xf
    v_perm_b32 v136, v22, v22, v8
    v_perm_b32 v137, v22, v22, v9
    v_perm_b32 v138, v22, v22, v10
    v_perm_b32 v139, v22, v22, v11
    s_waitcnt lgkmcnt(0)
    s_mul_i32 s69, s8, 0x9E3779B1
    s_add_u32 s69, s69, 0x7F4A7C15
    s_or_b32 s69, s69, 0x01010101
    s_xor_b32 s8, s8, s69
    s_lshr_b32 s9, s8, 8
    s_lshr_b32 s10, s8, 16
    s_lshr_b32 s11, s8, 24
    s_mov_b32 s12, 0x7060500
    s_mov_b32 s13, 0x7060501
    s_mov_b32 s14, 0x7060502
    s_mov_b32 s15, 0x7060503
    v_mov_b32 v12, s8
    v_lshlrev_b32 v13, 3, v1
    v_lshrrev_b32 v13, v13, v12
    v_and_b32 v245, 1, v1
    v_lshl_add_u32 v244, v2, 1, v245
    v_lshlrev_b32 v244, 3, v244
    v_lshrrev_b32 v244, v244, v12
    v_lshlrev_b32 v245, 3, v2
    v_lshrrev_b32 v245, v245, v12
    s_waitcnt vmcnt(8)
    v_mfma_f32_16x16x32_bf16 v[24:27], v[104:107], v[40:43], 0
    s_waitcnt vmcnt(7)
    v_mfma_f32_16x16x32_bf16 v[24:27], v[108:111], v[44:47], v[24:27]
    s_waitcnt vmcnt(6)
    v_mfma_f32_16x16x32_bf16 v[24:27], v[112:115], v[48:51], v[24:27]
    s_waitcnt vmcnt(5)
    v_mfma_f32_16x16x32_bf16 v[24:27], v[116:119], v[52:55], v[24:27]
    s_waitcnt vmcnt(4)
    v_mfma_f32_16x16x32_bf16 v[24:27], v[120:123], v[56:59], v[24:27]
    s_waitcnt vmcnt(3)
    v_mfma_f32_16x16x32_bf16 v[24:27], v[124:127], v[60:63], v[24:27]
    s_waitcnt vmcnt(2)
    v_mfma_f32_16x16x32_bf16 v[24:27], v[128:131], v[64:67], v[24:27]
    s_waitcnt vmcnt(1)
    v_mfma_f32_16x16x32_bf16 v[24:27], v[132:135], v[68:71], v[24:27]
    s_waitcnt vmcnt(0)
    v_mfma_f32_16x16x32_bf16 v[24:27], v[136:139], v[72:75], v[24:27]
    s_nop 7
    v_permlane32_swap_b32 v24, v28
    v_permlane32_swap_b32 v25, v29
    v_permlane32_swap_b32 v26, v30
    v_permlane32_swap_b32 v27, v31
    v_add_f32_dpp v24, v28, v24 row_ror:8 row_mask:0xf bank_mask:0xf
    v_add_f32_dpp v25, v29, v25 row_ror:8 row_mask:0xf bank_mask:0xf
    v_add_f32_dpp v26, v30, v26 row_ror:8 row_mask:0xf bank_mask:0xf
    v_add_f32_dpp v27, v31, v27 row_ror:8 row_mask:0xf bank_mask:0xf
    v_perm_b32 v24, v24, v244, s12
    s_mov_b64 exec, 0x00ff00ff
    buffer_store_dwordx4 v[24:27], v246, s[60:63], s97 offen sc1
    s_mov_b64 exec, 0xffff
    buffer_store_short v12, v15, s[60:63], s64 offen sc1
    s_mov_b64 exec, -1
    v_mov_b32 v21, 1
    s_mov_b64 exec, 1
    ds_add_u32 v247, v21 offset:36
    s_mov_b64 exec, -1
    s_branch L_c_s2w
L_c_nw:
    s_waitcnt lgkmcnt(0)
    s_mul_i32 s69, s8, 0x9E3779B1
    s_add_u32 s69, s69, 0x7F4A7C15
    s_or_b32 s69, s69, 0x01010101
    s_xor_b32 s8, s8, s69
    s_lshr_b32 s9, s8, 8
    s_lshr_b32 s10, s8, 16
    s_lshr_b32 s11, s8, 24
    s_mov_b32 s12, 0x7060500
    s_mov_b32 s13, 0x7060501
    s_mov_b32 s14, 0x7060502
    s_mov_b32 s15, 0x7060503
    v_mov_b32 v12, s8
    v_lshlrev_b32 v13, 3, v1
    v_lshrrev_b32 v13, v13, v12
    v_and_b32 v245, 1, v1
    v_lshl_add_u32 v244, v2, 1, v245
    v_lshlrev_b32 v244, 3, v244
    v_lshrrev_b32 v244, v244, v12
    v_lshlrev_b32 v245, 3, v2
    v_lshrrev_b32 v245, v245, v12
L_c_nw3:
    s_cmp_lg_u32 s6, 2
    s_cbranch_scc1 L_c_ea
    s_setprio 0
    s_mov_b32 s96, s3
    s_mul_i32 s69, s96, 995328
    s_lshl_b32 s70, s7, 7
    s_add_u32 s69, s69, s70
    s_add_u32 s69, s69, 2304
    s_add_u32 s52, s38, s69
    s_addc_u32 s53, s39, 0
    s_mov_b32 s54, 995328
    s_mov_b32 s55, 0x20000
    s_mov_b32 s64, 55296
    s_mov_b32 s70, 6912
    s_mov_b32 s71, 27648
    v_and_b32 v3, 7, v2
    v_lshlrev_b32 v3, 4, v3
    v_lshrrev_b32 v21, 3, v2
    v_mad_u32_u24 v16, v1, s70, v3
    v_mad_u32_u24 v16, v21, s71, v16
    s_mov_b32 s66, 0
    s_mov_b32 s67, 0
    s_mul_i32 s70, s96, 144
    v_lshl_add_u32 v3, v2, 3, v1
    v_add_lshl_u32 v3, v3, s70, 1
    global_load_short_d16_hi v36, v3, s[36:37]
    global_load_short_d16_hi v37, v3, s[36:37] offset:8
    v_and_b32 v3, 1, v2
    v_lshl_add_u32 v3, v3, 3, v1
    v_add_lshl_u32 v3, v3, s70, 1
    global_load_short_d16_hi v38, v3, s[36:37] offset:256
    global_load_short_d16_hi v39, v3, s[36:37] offset:264
    buffer_load_dwordx4 v[168:171], v16, s[52:55], s66 offen nt
    s_add_u32 s66, s66, s64
    buffer_load_dwordx4 v[172:175], v16, s[52:55], s66 offen nt
    s_add_u32 s66, s66, s64
    buffer_load_dwordx4 v[176:179], v16, s[52:55], s66 offen nt
    s_add_u32 s66, s66, s64
    s_waitcnt vmcnt(2)
    buffer_load_dwordx4 v[180:183], v16, s[52:55], s66 offen nt
    s_add_u32 s66, s66, s64
    s_waitcnt vmcnt(2)
    buffer_load_dwordx4 v[184:187], v16, s[52:55], s66 offen nt
    s_add_u32 s66, s66, s64
    s_waitcnt vmcnt(2)
    buffer_load_dwordx4 v[188:191], v16, s[52:55], s66 offen nt
    s_add_u32 s66, s66, s64
    s_waitcnt vmcnt(2)
    buffer_load_dwordx4 v[192:195], v16, s[52:55], s66 offen nt
    s_add_u32 s66, s66, s64
    s_waitcnt vmcnt(2)
    buffer_load_dwordx4 v[196:199], v16, s[52:55], s66 offen nt
    s_add_u32 s66, s66, s64
    s_waitcnt vmcnt(2)
    buffer_load_dwordx4 v[200:203], v16, s[52:55], s66 offen nt
    s_add_u32 s66, s66, s64
    s_waitcnt vmcnt(2)
    buffer_load_dwordx4 v[204:207], v16, s[52:55], s66 offen nt
    s_add_u32 s66, s66, s64
    s_waitcnt vmcnt(2)
    buffer_load_dwordx4 v[208:211], v16, s[52:55], s66 offen nt
    s_add_u32 s66, s66, s64
    s_waitcnt vmcnt(2)
    buffer_load_dwordx4 v[212:215], v16, s[52:55], s66 offen nt
    s_add_u32 s66, s66, s64
L_c_ea:
    s_cmp_eq_u32 s3, 3
    s_cbranch_scc1 L_c3_id
    s_branch L_c_s2w
L_c_wq:
    s_waitcnt vmcnt(16)
    v_lshlrev_b32 v28, 16, v20
    v_and_b32 v29, 0xffff0000, v20
    v_lshlrev_b32 v30, 16, v21
    v_and_b32 v31, 0xffff0000, v21
    v_lshlrev_b32 v32, 16, v22
    v_and_b32 v33, 0xffff0000, v22
    v_lshlrev_b32 v34, 16, v23
    v_and_b32 v35, 0xffff0000, v23
    v_lshlrev_b32 v36, 16, v24
    v_and_b32 v37, 0xffff0000, v24
    v_lshlrev_b32 v38, 16, v25
    v_and_b32 v39, 0xffff0000, v25
    v_cmp_gt_u32 vcc, 16, v0
    s_nop 1
    v_cndmask_b32 v36, 0, v36, vcc
    v_cndmask_b32 v37, 0, v37, vcc
    v_cndmask_b32 v38, 0, v38, vcc
    v_cndmask_b32 v39, 0, v39, vcc
    v_pk_add_f32 v[20:21], v[28:29], v[30:31]
    v_pk_add_f32 v[20:21], v[20:21], v[32:33]
    v_pk_add_f32 v[20:21], v[20:21], v[34:35]
    v_pk_add_f32 v[20:21], v[20:21], v[36:37]
    v_pk_add_f32 v[20:21], v[20:21], v[38:39]
    v_add_f32 v20, v20, v21
    s_nop 1
    v_add_f32_dpp v20, v20, v20 quad_perm:[1,0,3,2] row_mask:0xf bank_mask:0xf
    s_nop 1
    v_add_f32_dpp v20, v20, v20 quad_perm:[2,3,0,1] row_mask:0xf bank_mask:0xf
    s_nop 1
    v_add_f32_dpp v20, v20, v20 row_half_mirror row_mask:0xf bank_mask:0xf
    s_nop 1
    v_add_f32_dpp v20, v20, v20 row_mirror row_mask:0xf bank_mask:0xf
    s_nop 1
    v_add_f32_dpp v20, v20, v20 row_bcast:15 row_mask:0xa bank_mask:0xf
    s_nop 1
    v_add_f32_dpp v20, v20, v20 row_bcast:31 row_mask:0xc bank_mask:0xf
    s_nop 0
    v_readlane_b32 s70, v20, 63
    v_mov_b32 v20, 0x3ae38e39
    s_nop 0
    v_mul_f32 v20, s70, v20
    v_sub_f32 v28, v28, v20
    v_sub_f32 v29, v29, v20
    v_sub_f32 v30, v30, v20
    v_sub_f32 v31, v31, v20
    v_sub_f32 v32, v32, v20
    v_sub_f32 v33, v33, v20
    v_sub_f32 v34, v34, v20
    v_sub_f32 v35, v35, v20
    v_sub_f32 v36, v36, v20
    v_sub_f32 v37, v37, v20
    v_sub_f32 v38, v38, v20
    v_sub_f32 v39, v39, v20
    v_cndmask_b32 v36, 0, v36, vcc
    v_cndmask_b32 v37, 0, v37, vcc
    v_cndmask_b32 v38, 0, v38, vcc
    v_cndmask_b32 v39, 0, v39, vcc
    v_pk_mul_f32 v[22:23], v[28:29], v[28:29]
    v_pk_fma_f32 v[22:23], v[30:31], v[30:31], v[22:23]
    v_pk_fma_f32 v[22:23], v[32:33], v[32:33], v[22:23]
    v_pk_fma_f32 v[22:23], v[34:35], v[34:35], v[22:23]
    v_pk_fma_f32 v[22:23], v[36:37], v[36:37], v[22:23]
    v_pk_fma_f32 v[22:23], v[38:39], v[38:39], v[22:23]
    v_add_f32 v22, v22, v23
    s_nop 1
    v_add_f32_dpp v22, v22, v22 quad_perm:[1,0,3,2] row_mask:0xf bank_mask:0xf
    s_nop 1
    v_add_f32_dpp v22, v22, v22 quad_perm:[2,3,0,1] row_mask:0xf bank_mask:0xf
    s_nop 1
    v_add_f32_dpp v22, v22, v22 row_half_mirror row_mask:0xf bank_mask:0xf
    s_nop 1
    v_add_f32_dpp v22, v22, v22 row_mirror row_mask:0xf bank_mask:0xf
    s_nop 1
    v_add_f32_dpp v22, v22, v22 row_bcast:15 row_mask:0xa bank_mask:0xf
    s_nop 1
    v_add_f32_dpp v22, v22, v22 row_bcast:31 row_mask:0xc bank_mask:0xf
    s_nop 0
    v_readlane_b32 s70, v22, 63
    v_mov_b32 v22, 0x3ae38e39
    s_nop 0
    v_mul_f32 v22, s70, v22
    v_cvt_pk_bf16_f32 v20, v20, v20
    v_lshlrev_b32 v20, 16, v20
    v_cvt_pk_bf16_f32 v22, v22, v22
    v_lshlrev_b32 v22, 16, v22
    v_add_f32 v22, 0x3727c5ac, v22
    v_cvt_pk_bf16_f32 v22, v22, v22
    v_lshlrev_b32 v22, 16, v22
    v_sqrt_f32 v22, v22
    s_nop 0
    v_cvt_pk_bf16_f32 v22, v22, v22
    v_lshlrev_b32 v22, 16, v22
    v_sub_f32 v26, v26, v20
    v_cvt_pk_bf16_f32 v26, v26, v26
    v_lshlrev_b32 v26, 16, v26
    v_rcp_f32 v23, v22
    s_nop 0
    v_mul_f32 v21, v26, v23
    v_fma_f32 v24, -v21, v22, v26
    v_fma_f32 v21, v24, v23, v21
    v_cvt_pk_bf16_f32 v26, v21, v21
    v_lshlrev_b32 v26, 16, v26
    s_waitcnt lgkmcnt(0)
    s_mul_i32 s69, s8, 0x9E3779B1
    s_add_u32 s69, s69, 0x7F4A7C15
    s_or_b32 s69, s69, 0x01010101
    s_xor_b32 s8, s8, s69
    s_lshr_b32 s9, s8, 8
    s_lshr_b32 s10, s8, 16
    s_lshr_b32 s11, s8, 24
    s_mov_b32 s12, 0x7060500
    s_mov_b32 s13, 0x7060501
    s_mov_b32 s14, 0x7060502
    s_mov_b32 s15, 0x7060503
    v_mov_b32 v12, s8
    v_lshlrev_b32 v13, 3, v1
    v_lshrrev_b32 v13, v13, v12
    v_and_b32 v245, 1, v1
    v_lshl_add_u32 v244, v2, 1, v245
    v_lshlrev_b32 v244, 3, v244
    v_lshrrev_b32 v244, v244, v12
    v_lshlrev_b32 v245, 3, v2
    v_lshrrev_b32 v245, v245, v12
    v_mul_u32_u24 v3, 4608, v1
    v_lshl_add_u32 v3, v2, 4, v3
    s_lshl_b32 s70, s5, 8
    s_add_u32 s70, s70, 4096
    s_add_u32 s71, s70, 18432
    s_lshl_b32 s44, s4, 4
    s_add_u32 s44, s44, s5
    s_lshl_b32 s44, s44, 10
    s_lshl_b32 s45, s3, 9
    s_add_u32 s44, s44, s45
    s_add_u32 s97, s44, 261632
    s_mov_b32 s68, 800000
lw_20:
    ds_read_b32 v20, v247 offset:24
    s_waitcnt lgkmcnt(0)
    v_cmp_le_u32 vcc, 1, v20
    s_cbranch_vccnz lwd_21
    s_sleep 1
    s_sub_u32 s68, s68, 1
    s_cbranch_scc0 lw_20
lwd_21:
    s_mov_b32 s68, 20000
    buffer_load_dwordx4 v[120:123], v3, s[60:63], s70 offen offset:0 sc1
    buffer_load_dwordx4 v[124:127], v3, s[60:63], s71 offen offset:0 sc1
    buffer_load_dwordx4 v[128:131], v3, s[60:63], s70 offen offset:2304 sc1
    buffer_load_dwordx4 v[132:135], v3, s[60:63], s71 offen offset:2304 sc1
    v_mov_b32 v21, 1
    s_mov_b64 exec, 1
    ds_add_u32 v247, v21 offset:20
    s_mov_b64 exec, -1
poll_22:
    s_waitcnt vmcnt(0)
    v_xor_b32 v20, v245, v120
    v_bitop3_b32 v20, v124, v245, v20 bitop3:0xbe
    v_bitop3_b32 v20, v128, v245, v20 bitop3:0xbe
    v_bitop3_b32 v20, v132, v245, v20 bitop3:0xbe
    v_and_b32 v20, 0xff, v20
    v_cmp_ne_u32 vcc, 0, v20
    s_cbranch_vccz ok_24
    s_sub_u32 s68, s68, 1
    s_cbranch_scc1 ok_24
    buffer_load_dwordx4 v[120:123], v3, s[60:63], s70 offen offset:0 sc1
    buffer_load_dwordx4 v[124:127], v3, s[60:63], s71 offen offset:0 sc1
    buffer_load_dwordx4 v[128:131], v3, s[60:63], s70 offen offset:2304 sc1
    buffer_load_dwordx4 v[132:135], v3, s[60:63], s71 offen offset:2304 sc1
    s_branch poll_22
ok_24:
    v_pk_add_f32 v[28:29], v[120:121], v[124:125]
    v_pk_add_f32 v[30:31], v[122:123], v[126:127]
    v_pk_add_f32 v[32:33], v[128:129], v[132:133]
    v_pk_add_f32 v[34:35], v[130:131], v[134:135]
pd_23:
    v_permlane32_swap_b32 v28, v30
    v_permlane32_swap_b32 v29, v31
    v_permlane32_swap_b32 v32, v34
    v_permlane32_swap_b32 v33, v35
    v_pk_add_f32 v[28:29], v[28:29], v[30:31]
    v_pk_add_f32 v[32:33], v[32:33], v[34:35]
    s_nop 0
    v_permlane16_swap_b32 v28, v29
    v_permlane16_swap_b32 v32, v33
    v_add_f32 v28, v28, v29
    v_add_f32 v32, v32, v33
    v_cvt_pk_bf16_f32 v28, v28, v32
    v_and_b32 v32, 0xffff0000, v28
    v_lshlrev_b32 v28, 16, v28
    v_add_f32 v32, 1.0, v32
    v_cvt_pk_bf16_f32 v32, v32, v32
    v_lshlrev_b32 v32, 16, v32
    v_mul_f32 v26, v26, v32
    v_cvt_pk_bf16_f32 v26, v26, v26
    v_lshlrev_b32 v26, 16, v26
    v_add_f32 v26, v26, v28
    v_cvt_pk_bf16_f32 v26, v26, v26
    s_nop 1
    v_and_b32_dpp v104, v26, v4 row_newbcast:0 row_mask:0xf bank_mask:0xf
    v_and_b32_dpp v105, v26, v5 row_newbcast:0 row_mask:0xf bank_mask:0xf
    v_and_b32_dpp v106, v26, v6 row_newbcast:0 row_mask:0xf bank_mask:0xf
    v_and_b32_dpp v107, v26, v7 row_newbcast:0 row_mask:0xf bank_mask:0xf
    v_and_b32_dpp v108, v26, v4 row_newbcast:1 row_mask:0xf bank_mask:0xf
    v_and_b32_dpp v109, v26, v5 row_newbcast:1 row_mask:0xf bank_mask:0xf
    v_and_b32_dpp v110, v26, v6 row_newbcast:1 row_mask:0xf bank_mask:0xf
    v_and_b32_dpp v111, v26, v7 row_newbcast:1 row_mask:0xf bank_mask:0xf
    v_mfma_f32_16x16x32_bf16 v[28:31], v[104:107], v[40:43], 0
    v_and_b32_dpp v112, v26, v4 row_newbcast:2 row_mask:0xf bank_mask:0xf
    v_and_b32_dpp v113, v26, v5 row_newbcast:2 row_mask:0xf bank_mask:0xf
    v_and_b32_dpp v114, v26, v6 row_newbcast:2 row_mask:0xf bank_mask:0xf
    v_and_b32_dpp v115, v26, v7 row_newbcast:2 row_mask:0xf bank_mask:0xf
    v_mfma_f32_16x16x32_bf16 v[28:31], v[108:111], v[44:47], v[28:31]
    v_and_b32_dpp v104, v26, v4 row_newbcast:3 row_mask:0xf bank_mask:0xf
    v_and_b32_dpp v105, v26, v5 row_newbcast:3 row_mask:0xf bank_mask:0xf
    v_and_b32_dpp v106, v26, v6 row_newbcast:3 row_mask:0xf bank_mask:0xf
    v_and_b32_dpp v107, v26, v7 row_newbcast:3 row_mask:0xf bank_mask:0xf
    v_mfma_f32_16x16x32_bf16 v[28:31], v[112:115], v[48:51], v[28:31]
    v_and_b32_dpp v108, v26, v4 row_newbcast:4 row_mask:0xf bank_mask:0xf
    v_and_b32_dpp v109, v26, v5 row_newbcast:4 row_mask:0xf bank_mask:0xf
    v_and_b32_dpp v110, v26, v6 row_newbcast:4 row_mask:0xf bank_mask:0xf
    v_and_b32_dpp v111, v26, v7 row_newbcast:4 row_mask:0xf bank_mask:0xf
    v_mfma_f32_16x16x32_bf16 v[28:31], v[104:107], v[52:55], v[28:31]
    v_and_b32_dpp v112, v26, v4 row_newbcast:5 row_mask:0xf bank_mask:0xf
    v_and_b32_dpp v113, v26, v5 row_newbcast:5 row_mask:0xf bank_mask:0xf
    v_and_b32_dpp v114, v26, v6 row_newbcast:5 row_mask:0xf bank_mask:0xf
    v_and_b32_dpp v115, v26, v7 row_newbcast:5 row_mask:0xf bank_mask:0xf
    v_mfma_f32_16x16x32_bf16 v[28:31], v[108:111], v[56:59], v[28:31]
    v_and_b32_dpp v104, v26, v4 row_newbcast:6 row_mask:0xf bank_mask:0xf
    v_and_b32_dpp v105, v26, v5 row_newbcast:6 row_mask:0xf bank_mask:0xf
    v_and_b32_dpp v106, v26, v6 row_newbcast:6 row_mask:0xf bank_mask:0xf
    v_and_b32_dpp v107, v26, v7 row_newbcast:6 row_mask:0xf bank_mask:0xf
    v_mfma_f32_16x16x32_bf16 v[28:31], v[112:115], v[60:63], v[28:31]
    v_and_b32_dpp v108, v26, v4 row_newbcast:7 row_mask:0xf bank_mask:0xf
    v_and_b32_dpp v109, v26, v5 row_newbcast:7 row_mask:0xf bank_mask:0xf
    v_and_b32_dpp v110, v26, v6 row_newbcast:7 row_mask:0xf bank_mask:0xf
    v_and_b32_dpp v111, v26, v7 row_newbcast:7 row_mask:0xf bank_mask:0xf
    v_mfma_f32_16x16x32_bf16 v[28:31], v[104:107], v[64:67], v[28:31]
    v_and_b32_dpp v112, v26, v4 row_newbcast:8 row_mask:0xf bank_mask:0xf
    v_and_b32_dpp v113, v26, v5 row_newbcast:8 row_mask:0xf bank_mask:0xf
    v_and_b32_dpp v114, v26, v6 row_newbcast:8 row_mask:0xf bank_mask:0xf
    v_and_b32_dpp v115, v26, v7 row_newbcast:8 row_mask:0xf bank_mask:0xf
    v_mfma_f32_16x16x32_bf16 v[28:31], v[108:111], v[68:71], v[28:31]
    v_and_b32_dpp v104, v26, v4 row_newbcast:9 row_mask:0xf bank_mask:0xf
    v_and_b32_dpp v105, v26, v5 row_newbcast:9 row_mask:0xf bank_mask:0xf
    v_and_b32_dpp v106, v26, v6 row_newbcast:9 row_mask:0xf bank_mask:0xf
    v_and_b32_dpp v107, v26, v7 row_newbcast:9 row_mask:0xf bank_mask:0xf
    v_mfma_f32_16x16x32_bf16 v[28:31], v[112:115], v[72:75], v[28:31]
    v_and_b32_dpp v108, v26, v4 row_newbcast:10 row_mask:0xf bank_mask:0xf
    v_and_b32_dpp v109, v26, v5 row_newbcast:10 row_mask:0xf bank_mask:0xf
    v_and_b32_dpp v110, v26, v6 row_newbcast:10 row_mask:0xf bank_mask:0xf
    v_and_b32_dpp v111, v26, v7 row_newbcast:10 row_mask:0xf bank_mask:0xf
    v_mfma_f32_16x16x32_bf16 v[28:31], v[104:107], v[76:79], v[28:31]
    v_and_b32_dpp v112, v26, v4 row_newbcast:11 row_mask:0xf bank_mask:0xf
    v_and_b32_dpp v113, v26, v5 row_newbcast:11 row_mask:0xf bank_mask:0xf
    v_and_b32_dpp v114, v26, v6 row_newbcast:11 row_mask:0xf bank_mask:0xf
    v_and_b32_dpp v115, v26, v7 row_newbcast:11 row_mask:0xf bank_mask:0xf
    v_mfma_f32_16x16x32_bf16 v[28:31], v[108:111], v[80:83], v[28:31]
    v_and_b32_dpp v104, v26, v4 row_newbcast:12 row_mask:0xf bank_mask:0xf
    v_and_b32_dpp v105, v26, v5 row_newbcast:12 row_mask:0xf bank_mask:0xf
    v_and_b32_dpp v106, v26, v6 row_newbcast:12 row_mask:0xf bank_mask:0xf
    v_and_b32_dpp v107, v26, v7 row_newbcast:12 row_mask:0xf bank_mask:0xf
    v_mfma_f32_16x16x32_bf16 v[28:31], v[112:115], v[84:87], v[28:31]
    v_and_b32_dpp v108, v26, v4 row_newbcast:13 row_mask:0xf bank_mask:0xf
    v_and_b32_dpp v109, v26, v5 row_newbcast:13 row_mask:0xf bank_mask:0xf
    v_and_b32_dpp v110, v26, v6 row_newbcast:13 row_mask:0xf bank_mask:0xf
    v_and_b32_dpp v111, v26, v7 row_newbcast:13 row_mask:0xf bank_mask:0xf
    v_mfma_f32_16x16x32_bf16 v[28:31], v[104:107], v[88:91], v[28:31]
    v_and_b32_dpp v112, v26, v4 row_newbcast:14 row_mask:0xf bank_mask:0xf
    v_and_b32_dpp v113, v26, v5 row_newbcast:14 row_mask:0xf bank_mask:0xf
    v_and_b32_dpp v114, v26, v6 row_newbcast:14 row_mask:0xf bank_mask:0xf
    v_and_b32_dpp v115, v26, v7 row_newbcast:14 row_mask:0xf bank_mask:0xf
    ds_read_b32 v21, v247 offset:28
    v_mfma_f32_16x16x32_bf16 v[28:31], v[108:111], v[92:95], v[28:31]
    v_and_b32_dpp v104, v26, v4 row_newbcast:15 row_mask:0xf bank_mask:0xf
    v_and_b32_dpp v105, v26, v5 row_newbcast:15 row_mask:0xf bank_mask:0xf
    v_and_b32_dpp v106, v26, v6 row_newbcast:15 row_mask:0xf bank_mask:0xf
    v_and_b32_dpp v107, v26, v7 row_newbcast:15 row_mask:0xf bank_mask:0xf
    v_mfma_f32_16x16x32_bf16 v[28:31], v[112:115], v[96:99], v[28:31]
    s_nop 0
    v_mfma_f32_16x16x32_bf16 v[28:31], v[104:107], v[100:103], v[28:31]
    s_waitcnt lgkmcnt(0)
    v_readfirstlane_b32 s27, v21
    s_nop 5
    v_perm_b32 v28, v28, v244, s12
    s_mov_b32 exec_hi, 0
    s_cmp_eq_u32 s27, 2
    s_cbranch_scc0 ps_25
    buffer_store_dwordx4 v[28:31], v246, s[60:63], s97 offen
pe_26:
    s_mov_b64 exec, -1
    v_mov_b32 v21, 1
    s_mov_b64 exec, 1
    ds_add_u32 v247, v21 offset:4
    s_mov_b64 exec, -1
L_c_s2w:
    v_lshlrev_b32 v3, 10, v1
    v_lshl_add_u32 v3, v2, 4, v3
    s_lshl_b32 s70, s4, 14
    s_lshl_b32 s71, s3, 8
    s_add_u32 s70, s70, s71
    s_add_u32 s44, s70, 262144
    s_add_u32 s45, s44, 4096
    s_add_u32 s46, s44, 8192
    v_lshl_add_u32 v14, v2, 2, v1
    s_lshl_b32 s70, s3, 6
    v_add_lshl_u32 v14, v14, s70, 1
    v_and_b32 v144, 0xff, v245
    v_mov_b32 v145, 0
    v_mov_b32 v146, 0
    v_mov_b32 v147, 0
    s_mov_b32 s68, 800000
lw_27:
    ds_read_b32 v20, v247 offset:4
    s_waitcnt lgkmcnt(0)
    v_cmp_le_u32 vcc, 2, v20
    s_cbranch_vccnz lwd_28
    s_sleep 1
    s_sub_u32 s68, s68, 1
    s_cbranch_scc0 lw_27
lwd_28:
    s_mov_b32 s68, 20000
    buffer_load_dwordx4 v[136:139], v3, s[60:63], s44 offen sc1
    buffer_load_dwordx4 v[140:143], v3, s[60:63], s45 offen sc1
    s_mov_b64 exec, 0xffff
    buffer_load_dwordx4 v[144:147], v3, s[60:63], s46 offen sc1
    s_mov_b64 exec, -1
poll_29:
    s_waitcnt vmcnt(0)
    v_xor_b32 v20, v245, v136
    v_bitop3_b32 v20, v140, v245, v20 bitop3:0xbe
    v_bitop3_b32 v20, v144, v245, v20 bitop3:0xbe
    v_and_b32 v20, 0xff, v20
    v_cmp_ne_u32 vcc, 0, v20
    s_cbranch_vccz ok_31
    s_sub_u32 s68, s68, 1
    s_cbranch_scc1 ok_31
    buffer_load_dwordx4 v[136:139], v3, s[60:63], s44 offen sc1
    buffer_load_dwordx4 v[140:143], v3, s[60:63], s45 offen sc1
    s_mov_b64 exec, 0xffff
    buffer_load_dwordx4 v[144:147], v3, s[60:63], s46 offen sc1
    s_mov_b64 exec, -1
    s_branch poll_29
ok_31:
    v_pk_add_f32 v[28:29], v[136:137], v[140:141]
    v_pk_add_f32 v[30:31], v[138:139], v[142:143]
    v_pk_add_f32 v[28:29], v[28:29], v[144:145]
    v_pk_add_f32 v[30:31], v[30:31], v[146:147]
pd_30:
    s_nop 1
    v_permlane32_swap_b32 v28, v30
    v_permlane32_swap_b32 v29, v31
    v_pk_add_f32 v[28:29], v[28:29], v[30:31]
    s_nop 1
    v_permlane16_swap_b32 v28, v29
    v_add_f32 v28, v28, v29
    v_cvt_pk_bf16_f32 v20, v28, v28
    ds_write_b16 v14, v20 offset:256
    v_mov_b32 v21, 1
    s_mov_b64 exec, 1
    ds_add_u32 v247, v21 offset:0
    s_mov_b64 exec, -1
    s_cmp_lg_u32 s3, 3
    s_cbranch_scc1 L_nopl
    s_lshl_b32 s69, s4, 4
    s_add_u32 s69, s69, s5
    v_lshlrev_b32 v3, 7, v0
    s_mul_i32 s70, s69, 1152
    s_add_u32 s70, s70, 524288
    s_mov_b64 exec, 0x1ff
    buffer_load_dword v232, v3, s[60:63], s70 offen
    s_mov_b32 exec_hi, 0
    s_mul_i32 s70, s4, 2304
    s_lshl_b32 s71, s7, 8
    s_add_u32 s70, s70, s71
    s_add_u32 s70, s70, 53248
    s_add_u32 s71, s71, 40960
    s_cmp_eq_u32 s6, 2
    s_cselect_b32 s70, s71, s70
    s_mul_i32 s71, s7, 2304
    s_add_u32 s71, s71, 90112
    s_cmp_eq_u32 s6, 1
    s_cselect_b32 s70, s71, s70
    s_cselect_b32 exec_lo, 0x3ffff, 3
    s_cmp_eq_u32 s6, 3
    s_cselect_b32 s70, 53248, s70
    buffer_load_dword v233, v3, s[60:63], s70 offen
    s_mov_b64 exec, -1
L_nopl:
    s_cmp_eq_u32 s6, 1
    s_cbranch_scc1 L_c_m
    s_cmp_eq_u32 s6, 2
    s_cbranch_scc1 L_c_b
    s_cmp_lg_u32 s3, 3
    s_cbranch_scc1 L_c_end
    s_mov_b32 s7, s4
    s_cmp_eq_u32 s5, 8
    s_cbranch_scc1 L_red
    s_add_u32 s7, s4, 16
    s_cmp_lg_u32 s5, 7
    s_cbranch_scc1 L_c_end
    s_cmp_lt_u32 s4, 2
    s_cbranch_scc1 L_red
L_c_end:
    s_endpgm
L_c_b:
    s_mov_b32 s96, s3
    s_mov_b32 s23, s66
    s_mul_i32 s69, s96, 995328
    s_lshl_b32 s70, s7, 7
    s_add_u32 s69, s69, s70
    s_add_u32 s69, s69, 2304
    s_add_u32 s52, s38, s69
    s_addc_u32 s53, s39, 0
    s_mov_b32 s54, 995328
    s_mov_b32 s55, 0x20000
    s_mov_b32 s64, 55296
    s_mov_b32 s70, 6912
    s_mov_b32 s71, 27648
    v_and_b32 v3, 7, v2
    v_lshlrev_b32 v3, 4, v3
    v_lshrrev_b32 v21, 3, v2
    v_mad_u32_u24 v16, v1, s70, v3
    v_mad_u32_u24 v16, v21, s71, v16
    s_mov_b32 s66, 0
    s_mov_b32 s67, 0
    s_mov_b32 s66, 663552
    buffer_load_dwordx4 v[216:219], v16, s[52:55], s66 offen nt
    s_add_u32 s66, s66, s64
    buffer_load_dwordx4 v[220:223], v16, s[52:55], s66 offen nt
    s_add_u32 s66, s66, s64
    buffer_load_dwordx4 v[224:227], v16, s[52:55], s66 offen nt
    s_add_u32 s66, s66, s64
    buffer_load_dwordx4 v[228:231], v16, s[52:55], s66 offen nt
    s_add_u32 s66, s66, s64
    buffer_load_dwordx4 v[232:235], v16, s[52:55], s66 offen nt
    s_add_u32 s66, s66, s64
    buffer_load_dwordx4 v[236:239], v16, s[52:55], s66 offen nt
    s_add_u32 s66, s66, s64
    s_waitcnt vmcnt(6)
    v_mul_f32 v32, 0xbfb8aa3b, v36
    v_mul_f32 v33, 0xbfb8aa3b, v37
    v_mul_f32 v34, 0xbfb8aa3b, v38
    v_mul_f32 v35, 0xbfb8aa3b, v39
    v_exp_f32 v32, v32
    v_exp_f32 v33, v33
    v_exp_f32 v34, v34
    v_exp_f32 v35, v35
    v_add_f32 v32, 1.0, v32
    v_add_f32 v33, 1.0, v33
    v_add_f32 v34, 1.0, v34
    v_add_f32 v35, 1.0, v35
    v_rcp_f32 v32, v32
    v_rcp_f32 v33, v33
    v_rcp_f32 v34, v34
    v_rcp_f32 v35, v35
    v_mul_f32 v36, v36, v32
    v_mul_f32 v37, v37, v33
    v_mul_f32 v38, v38, v34
    v_mul_f32 v39, v39, v35
    v_cvt_pk_bf16_f32 v39, v38, v39
    v_cvt_pk_bf16_f32 v38, v36, v37
    s_lshl_b32 s70, s3, 10
    v_lshlrev_b32 v20, 4, v0
    v_add_u32 v21, s70, v20
    s_lshl_b32 s70, s7, 8
    s_add_u32 s70, s70, 40960
    v_mov_b32_dpp v30, v38 row_newbcast:0 row_mask:0xf bank_mask:0xf
    v_perm_b32 v40, v30, v30, v8
    v_perm_b32 v41, v30, v30, v9
    v_perm_b32 v42, v30, v30, v10
    v_perm_b32 v43, v30, v30, v11
    v_mov_b32_dpp v31, v38 row_newbcast:1 row_mask:0xf bank_mask:0xf
    v_perm_b32 v44, v31, v31, v8
    v_perm_b32 v45, v31, v31, v9
    v_perm_b32 v46, v31, v31, v10
    v_perm_b32 v47, v31, v31, v11
    s_waitcnt vmcnt(6)
    v_mfma_f32_16x16x32_bf16 v[240:243], v[40:43], v[168:171], 0
    v_mov_b32_dpp v30, v38 row_newbcast:2 row_mask:0xf bank_mask:0xf
    v_perm_b32 v48, v30, v30, v8
    v_perm_b32 v49, v30, v30, v9
    v_perm_b32 v50, v30, v30, v10
    v_perm_b32 v51, v30, v30, v11
    s_waitcnt vmcnt(6)
    v_mfma_f32_16x16x32_bf16 v[240:243], v[44:47], v[172:175], v[240:243]
    v_mov_b32_dpp v31, v38 row_newbcast:3 row_mask:0xf bank_mask:0xf
    v_perm_b32 v40, v31, v31, v8
    v_perm_b32 v41, v31, v31, v9
    v_perm_b32 v42, v31, v31, v10
    v_perm_b32 v43, v31, v31, v11
    s_waitcnt vmcnt(6)
    v_mfma_f32_16x16x32_bf16 v[240:243], v[48:51], v[176:179], v[240:243]
    v_mov_b32_dpp v30, v38 row_newbcast:4 row_mask:0xf bank_mask:0xf
    v_perm_b32 v44, v30, v30, v8
    v_perm_b32 v45, v30, v30, v9
    v_perm_b32 v46, v30, v30, v10
    v_perm_b32 v47, v30, v30, v11
    s_waitcnt vmcnt(6)
    v_mfma_f32_16x16x32_bf16 v[240:243], v[40:43], v[180:183], v[240:243]
    v_mov_b32_dpp v31, v38 row_newbcast:5 row_mask:0xf bank_mask:0xf
    v_perm_b32 v48, v31, v31, v8
    v_perm_b32 v49, v31, v31, v9
    v_perm_b32 v50, v31, v31, v10
    v_perm_b32 v51, v31, v31, v11
    s_waitcnt vmcnt(6)
    v_mfma_f32_16x16x32_bf16 v[240:243], v[44:47], v[184:187], v[240:243]
    v_mov_b32_dpp v30, v38 row_newbcast:6 row_mask:0xf bank_mask:0xf
    v_perm_b32 v40, v30, v30, v8
    v_perm_b32 v41, v30, v30, v9
    v_perm_b32 v42, v30, v30, v10
    v_perm_b32 v43, v30, v30, v11
    s_waitcnt vmcnt(6)
    v_mfma_f32_16x16x32_bf16 v[240:243], v[48:51], v[188:191], v[240:243]
    v_mov_b32_dpp v31, v38 row_newbcast:7 row_mask:0xf bank_mask:0xf
    v_perm_b32 v44, v31, v31, v8
    v_perm_b32 v45, v31, v31, v9
    v_perm_b32 v46, v31, v31, v10
    v_perm_b32 v47, v31, v31, v11
    s_waitcnt vmcnt(6)
    v_mfma_f32_16x16x32_bf16 v[240:243], v[40:43], v[192:195], v[240:243]
    v_mov_b32_dpp v30, v38 row_newbcast:8 row_mask:0xf bank_mask:0xf
    v_perm_b32 v48, v30, v30, v8
    v_perm_b32 v49, v30, v30, v9
    v_perm_b32 v50, v30, v30, v10
    v_perm_b32 v51, v30, v30, v11
    s_waitcnt vmcnt(6)
    v_mfma_f32_16x16x32_bf16 v[240:243], v[44:47], v[196:199], v[240:243]
    v_mov_b32_dpp v31, v38 row_newbcast:9 row_mask:0xf bank_mask:0xf
    v_perm_b32 v40, v31, v31, v8
    v_perm_b32 v41, v31, v31, v9
    v_perm_b32 v42, v31, v31, v10
    v_perm_b32 v43, v31, v31, v11
    s_waitcnt vmcnt(6)
    v_mfma_f32_16x16x32_bf16 v[240:243], v[48:51], v[200:203], v[240:243]
    v_mov_b32_dpp v30, v38 row_newbcast:10 row_mask:0xf bank_mask:0xf
    v_perm_b32 v44, v30, v30, v8
    v_perm_b32 v45, v30, v30, v9
    v_perm_b32 v46, v30, v30, v10
    v_perm_b32 v47, v30, v30, v11
    s_waitcnt vmcnt(6)
    v_mfma_f32_16x16x32_bf16 v[240:243], v[40:43], v[204:207], v[240:243]
    v_mov_b32_dpp v31, v38 row_newbcast:11 row_mask:0xf bank_mask:0xf
    v_perm_b32 v48, v31, v31, v8
    v_perm_b32 v49, v31, v31, v9
    v_perm_b32 v50, v31, v31, v10
    v_perm_b32 v51, v31, v31, v11
    s_waitcnt vmcnt(6)
    v_mfma_f32_16x16x32_bf16 v[240:243], v[44:47], v[208:211], v[240:243]
    v_mov_b32_dpp v30, v38 row_newbcast:12 row_mask:0xf bank_mask:0xf
    v_perm_b32 v40, v30, v30, v8
    v_perm_b32 v41, v30, v30, v9
    v_perm_b32 v42, v30, v30, v10
    v_perm_b32 v43, v30, v30, v11
    s_waitcnt vmcnt(6)
    v_mfma_f32_16x16x32_bf16 v[240:243], v[48:51], v[212:215], v[240:243]
    v_mov_b32_dpp v31, v38 row_newbcast:13 row_mask:0xf bank_mask:0xf
    v_perm_b32 v44, v31, v31, v8
    v_perm_b32 v45, v31, v31, v9
    v_perm_b32 v46, v31, v31, v10
    v_perm_b32 v47, v31, v31, v11
    s_waitcnt vmcnt(5)
    v_mfma_f32_16x16x32_bf16 v[240:243], v[40:43], v[216:219], v[240:243]
    v_mov_b32_dpp v30, v38 row_newbcast:14 row_mask:0xf bank_mask:0xf
    v_perm_b32 v48, v30, v30, v8
    v_perm_b32 v49, v30, v30, v9
    v_perm_b32 v50, v30, v30, v10
    v_perm_b32 v51, v30, v30, v11
    s_waitcnt vmcnt(4)
    v_mfma_f32_16x16x32_bf16 v[240:243], v[44:47], v[220:223], v[240:243]
    v_mov_b32_dpp v31, v38 row_newbcast:15 row_mask:0xf bank_mask:0xf
    v_perm_b32 v40, v31, v31, v8
    v_perm_b32 v41, v31, v31, v9
    v_perm_b32 v42, v31, v31, v10
    v_perm_b32 v43, v31, v31, v11
    s_waitcnt vmcnt(3)
    v_mfma_f32_16x16x32_bf16 v[240:243], v[48:51], v[224:227], v[240:243]
    v_mov_b32_dpp v30, v39 row_newbcast:0 row_mask:0xf bank_mask:0xf
    v_perm_b32 v44, v30, v30, v8
    v_perm_b32 v45, v30, v30, v9
    v_perm_b32 v46, v30, v30, v10
    v_perm_b32 v47, v30, v30, v11
    s_waitcnt vmcnt(2)
    v_mfma_f32_16x16x32_bf16 v[240:243], v[40:43], v[228:231], v[240:243]
    v_mov_b32_dpp v31, v39 row_newbcast:1 row_mask:0xf bank_mask:0xf
    v_perm_b32 v48, v31, v31, v8
    v_perm_b32 v49, v31, v31, v9
    v_perm_b32 v50, v31, v31, v10
    v_perm_b32 v51, v31, v31, v11
    s_waitcnt vmcnt(1)
    v_mfma_f32_16x16x32_bf16 v[240:243], v[44:47], v[232:235], v[240:243]
    s_waitcnt vmcnt(0)
    v_mfma_f32_16x16x32_bf16 v[240:243], v[48:51], v[236:239], v[240:243]
    s_nop 7
    ds_write_b128 v21, v[240:243] offset:5120
    v_mov_b32 v26, 1
    s_mov_b64 exec, 1
    ds_add_rtn_u32 v26, v247, v26 offset:16
    s_waitcnt lgkmcnt(0)
    v_cmp_eq_u32 vcc, 3, v26
    s_mov_b64 exec, -1
    s_cbranch_vccz L_c_end
    ds_read_b128 v[40:43], v20 offset:5120
    ds_read_b128 v[44:47], v20 offset:6144
    ds_read_b128 v[48:51], v20 offset:7168
    ds_read_b128 v[52:55], v20 offset:8192
    s_waitcnt lgkmcnt(0)
    v_pk_add_f32 v[40:41], v[40:41], v[44:45]
    v_pk_add_f32 v[42:43], v[42:43], v[46:47]
    v_pk_add_f32 v[48:49], v[48:49], v[52:53]
    v_pk_add_f32 v[50:51], v[50:51], v[54:55]
    v_pk_add_f32 v[40:41], v[40:41], v[48:49]
    v_pk_add_f32 v[42:43], v[42:43], v[50:51]
    s_nop 0
    v_permlane32_swap_b32 v40, v44
    v_permlane32_swap_b32 v41, v45
    v_permlane32_swap_b32 v42, v46
    v_permlane32_swap_b32 v43, v47
    v_add_f32_dpp v40, v44, v40 row_ror:8 row_mask:0xf bank_mask:0xf
    v_add_f32_dpp v41, v45, v41 row_ror:8 row_mask:0xf bank_mask:0xf
    v_add_f32_dpp v42, v46, v42 row_ror:8 row_mask:0xf bank_mask:0xf
    v_add_f32_dpp v43, v47, v43 row_ror:8 row_mask:0xf bank_mask:0xf
    v_cvt_pk_bf16_f32 v40, v40, v40
    v_lshlrev_b32 v40, 16, v40
    v_cvt_pk_bf16_f32 v41, v41, v41
    v_lshlrev_b32 v41, 16, v41
    v_cvt_pk_bf16_f32 v42, v42, v42
    v_lshlrev_b32 v42, 16, v42
    v_cvt_pk_bf16_f32 v43, v43, v43
    v_lshlrev_b32 v43, 16, v43
    v_perm_b32 v40, v40, v12, s12
    v_perm_b32 v41, v41, v12, s13
    v_perm_b32 v42, v42, v12, s14
    v_perm_b32 v43, v43, v12, s15
    s_mov_b64 exec, 0x00ff00ff
    buffer_store_dwordx4 v[40:43], v246, s[60:63], s70 offen sc1
    s_branch L_c_end
L_red:
    v_and_b32 v14, 7, v2
    v_lshl_add_u32 v15, v14, 2, v1
    s_lshl_b32 s70, s7, 5
    v_add_u32 v15, s70, v15
    v_lshlrev_b32 v18, 1, v15
    v_lshlrev_b32 v15, 2, v15
    v_lshrrev_b32 v3, 3, v0
    v_mul_u32_u24 v3, 2304, v3
    v_lshl_add_u32 v3, v14, 4, v3
    s_lshl_b32 s70, s7, 7
    v_add_u32 v3, s70, v3
    s_mov_b32 s44, 53248
    s_mov_b32 s45, 71680
    s_mov_b32 s46, 40960
    s_mov_b32 s47, 47872
    s_lshl_b32 s23, s4, 4
    s_add_u32 s23, s23, 9
    s_mul_i32 s23, s23, 1152
    s_add_u32 s23, s23, 524288
    s_mov_b32 s68, 800000
lw_32:
    ds_read_b32 v20, v247 offset:16
    s_waitcnt lgkmcnt(0)
    v_cmp_le_u32 vcc, 4, v20
    s_cbranch_vccnz lwd_33
    s_sleep 1
    s_sub_u32 s68, s68, 1
    s_cbranch_scc0 lw_32
lwd_33:
    s_mov_b32 s68, 20000
    buffer_load_dwordx4 v[32:35], v247, s[60:63], s23 offen offset:1056 sc1
poll_34:
    s_waitcnt vmcnt(0)
    v_xor_b32 v20, s8, v32
    v_bitop3_b32 v20, v33, s9, v20 bitop3:0xbe
    v_bitop3_b32 v20, v34, s10, v20 bitop3:0xbe
    v_bitop3_b32 v20, v35, s11, v20 bitop3:0xbe
    v_and_b32 v20, 0xff, v20
    v_cmp_ne_u32 vcc, 0, v20
    s_cbranch_vccz ok_36
    s_sub_u32 s68, s68, 1
    s_cbranch_scc1 ok_36
    s_sleep 4
    buffer_load_dwordx4 v[32:35], v247, s[60:63], s23 offen offset:1056 sc1
    s_branch poll_34
ok_36:
pd_35:
    global_load_short_d16_hi v24, v18, s[16:17]
    global_load_short_d16_hi v25, v18, s[34:35]
    s_mov_b32 s68, 20000
    buffer_load_dwordx4 v[40:43], v3, s[60:63], s44 offen sc1
    buffer_load_dwordx4 v[44:47], v3, s[60:63], s45 offen sc1
    buffer_load_dword v26, v15, s[60:63], s46 offen sc1
    buffer_load_dword v27, v15, s[60:63], s47 offen sc1
poll_37:
    s_waitcnt vmcnt(0)
    v_xor_b32 v20, v245, v40
    v_bitop3_b32 v20, v44, v245, v20 bitop3:0xbe
    v_bitop3_b32 v20, v26, v13, v20 bitop3:0xbe
    v_bitop3_b32 v20, v27, v13, v20 bitop3:0xbe
    v_and_b32 v20, 0xff, v20
    v_cmp_ne_u32 vcc, 0, v20
    s_cbranch_vccz ok_39
    s_sub_u32 s68, s68, 1
    s_cbranch_scc1 ok_39
    s_sleep 4
    buffer_load_dwordx4 v[40:43], v3, s[60:63], s44 offen sc1
    buffer_load_dwordx4 v[44:47], v3, s[60:63], s45 offen sc1
    buffer_load_dword v26, v15, s[60:63], s46 offen sc1
    buffer_load_dword v27, v15, s[60:63], s47 offen sc1
    s_branch poll_37
ok_39:
pd_38:
    v_pk_add_f32 v[40:41], v[40:41], v[44:45]
    v_pk_add_f32 v[42:43], v[42:43], v[46:47]
    s_nop 1
    v_permlane32_swap_b32 v40, v42
    v_permlane32_swap_b32 v41, v43
    v_pk_add_f32 v[40:41], v[40:41], v[42:43]
    s_nop 1
    v_permlane16_swap_b32 v40, v41
    v_add_f32 v40, v40, v41
    s_nop 1
    v_add_f32_dpp v40, v40, v40 row_ror:8 row_mask:0xf bank_mask:0xf
    v_and_b32 v26, 0xffff0000, v26
    v_and_b32 v27, 0xffff0000, v27
    v_cvt_pk_bf16_f32 v40, v40, v40
    v_lshlrev_b32 v40, 16, v40
    v_mul_f32 v40, v40, v26
    v_cvt_pk_bf16_f32 v40, v40, v40
    v_lshlrev_b32 v40, 16, v40
    v_add_f32 v24, v24, v40
    v_cvt_pk_bf16_f32 v24, v24, v24
    v_lshlrev_b32 v24, 16, v24
    s_mov_b32 s44, 90112
    s_mov_b32 s45, 108544
    s_mov_b32 s46, 126976
    s_mov_b32 s47, 145408
    s_mov_b32 s48, 163840
    s_mov_b32 s49, 182272
    s_mov_b32 s50, 200704
    s_mov_b32 s51, 219136
    s_mov_b32 s52, 237568
    s_mov_b32 s68, 20000
    buffer_load_dwordx4 v[32:35], v247, s[60:63], s23 offen offset:1072 sc1
poll_40:
    s_waitcnt vmcnt(0)
    v_xor_b32 v20, s8, v32
    v_bitop3_b32 v20, v33, s9, v20 bitop3:0xbe
    v_bitop3_b32 v20, v34, s10, v20 bitop3:0xbe
    v_bitop3_b32 v20, v35, s11, v20 bitop3:0xbe
    v_and_b32 v20, 0xff, v20
    v_cmp_ne_u32 vcc, 0, v20
    s_cbranch_vccz ok_42
    s_sub_u32 s68, s68, 1
    s_cbranch_scc1 ok_42
    buffer_load_dwordx4 v[32:35], v247, s[60:63], s23 offen offset:1072 sc1
    s_branch poll_40
ok_42:
pd_41:
    s_mov_b32 s68, 20000
    buffer_load_dwordx4 v[40:43], v3, s[60:63], s44 offen sc1
    buffer_load_dwordx4 v[44:47], v3, s[60:63], s45 offen sc1
    buffer_load_dwordx4 v[48:51], v3, s[60:63], s46 offen sc1
    buffer_load_dwordx4 v[52:55], v3, s[60:63], s47 offen sc1
    buffer_load_dwordx4 v[56:59], v3, s[60:63], s48 offen sc1
    buffer_load_dwordx4 v[60:63], v3, s[60:63], s49 offen sc1
    buffer_load_dwordx4 v[64:67], v3, s[60:63], s50 offen sc1
    buffer_load_dwordx4 v[68:71], v3, s[60:63], s51 offen sc1
    buffer_load_dwordx4 v[72:75], v3, s[60:63], s52 offen sc1
poll_43:
    s_waitcnt vmcnt(0)
    v_xor_b32 v20, v245, v40
    v_bitop3_b32 v20, v44, v245, v20 bitop3:0xbe
    v_bitop3_b32 v20, v48, v245, v20 bitop3:0xbe
    v_bitop3_b32 v20, v52, v245, v20 bitop3:0xbe
    v_bitop3_b32 v20, v56, v245, v20 bitop3:0xbe
    v_bitop3_b32 v20, v60, v245, v20 bitop3:0xbe
    v_bitop3_b32 v20, v64, v245, v20 bitop3:0xbe
    v_bitop3_b32 v20, v68, v245, v20 bitop3:0xbe
    v_bitop3_b32 v20, v72, v245, v20 bitop3:0xbe
    v_and_b32 v20, 0xff, v20
    v_cmp_ne_u32 vcc, 0, v20
    s_cbranch_vccz ok_45
    s_sub_u32 s68, s68, 1
    s_cbranch_scc1 ok_45
    buffer_load_dwordx4 v[40:43], v3, s[60:63], s44 offen sc1
    buffer_load_dwordx4 v[44:47], v3, s[60:63], s45 offen sc1
    buffer_load_dwordx4 v[48:51], v3, s[60:63], s46 offen sc1
    buffer_load_dwordx4 v[52:55], v3, s[60:63], s47 offen sc1
    buffer_load_dwordx4 v[56:59], v3, s[60:63], s48 offen sc1
    buffer_load_dwordx4 v[60:63], v3, s[60:63], s49 offen sc1
    buffer_load_dwordx4 v[64:67], v3, s[60:63], s50 offen sc1
    buffer_load_dwordx4 v[68:71], v3, s[60:63], s51 offen sc1
    buffer_load_dwordx4 v[72:75], v3, s[60:63], s52 offen sc1
    s_branch poll_43
ok_45:
    v_pk_add_f32 v[40:41], v[40:41], v[72:73]
    v_pk_add_f32 v[42:43], v[42:43], v[74:75]
    v_pk_add_f32 v[40:41], v[40:41], v[44:45]
    v_pk_add_f32 v[42:43], v[42:43], v[46:47]
    v_pk_add_f32 v[48:49], v[48:49], v[52:53]
    v_pk_add_f32 v[50:51], v[50:51], v[54:55]
    v_pk_add_f32 v[28:29], v[40:41], v[48:49]
    v_pk_add_f32 v[30:31], v[42:43], v[50:51]
    v_pk_add_f32 v[56:57], v[56:57], v[60:61]
    v_pk_add_f32 v[58:59], v[58:59], v[62:63]
    v_pk_add_f32 v[64:65], v[64:65], v[68:69]
    v_pk_add_f32 v[66:67], v[66:67], v[70:71]
    v_pk_add_f32 v[32:33], v[56:57], v[64:65]
    v_pk_add_f32 v[34:35], v[58:59], v[66:67]
    v_pk_add_f32 v[28:29], v[28:29], v[32:33]
    v_pk_add_f32 v[30:31], v[30:31], v[34:35]
pd_44:
    s_nop 1
    v_permlane32_swap_b32 v28, v30
    v_permlane32_swap_b32 v29, v31
    v_pk_add_f32 v[28:29], v[28:29], v[30:31]
    s_nop 1
    v_permlane16_swap_b32 v28, v29
    v_add_f32 v28, v28, v29
    s_nop 1
    v_add_f32_dpp v28, v28, v28 row_ror:8 row_mask:0xf bank_mask:0xf
    v_cvt_pk_bf16_f32 v28, v28, v28
    v_lshlrev_b32 v28, 16, v28
    v_add_f32 v28, v28, v25
    v_cvt_pk_bf16_f32 v28, v28, v28
    v_lshlrev_b32 v28, 16, v28
    v_mul_f32 v28, v28, v27
    v_cvt_pk_bf16_f32 v28, v28, v28
    v_lshlrev_b32 v28, 16, v28
    v_add_f32 v28, v28, v24
    v_cvt_pk_bf16_f32 v28, v28, v28
    s_mov_b32 exec_lo, 0x00ff00ff
    s_mov_b32 exec_hi, 0x00ff00ff
    global_store_short v18, v28, s[40:41]
    s_cmp_lg_u32 s7, 0
    s_cbranch_scc1 L_red_end
    s_mov_b64 exec, 1
    global_store_dword v247, v12, s[42:43] offset:0 sc1
L_red_end:
    s_endpgm
L_c_m:
    s_setprio 0
    v_lshl_add_u32 v14, v2, 2, v1
    s_lshl_b32 s70, s3, 6
    v_add_u32 v15, s70, v14
    v_lshlrev_b32 v3, 1, v15
    global_load_short_d16_hi v24, v3, s[16:17]
    v_lshlrev_b32 v3, 1, v14
    global_load_short_d16_hi v25, v3, s[16:17] offset:1024
    s_lshl_b32 s70, s7, 7
    v_add_u32 v3, s70, v3
    global_load_short_d16_hi v23, v3, s[30:31]
    s_mul_i32 s69, s3, 1327104
    s_lshl_b32 s70, s7, 7
    s_add_u32 s69, s69, s70
    s_add_u32 s52, s28, s69
    s_addc_u32 s53, s29, 0
    s_mov_b32 s54, 1327104
    s_mov_b32 s55, 0x20000
    s_mov_b32 s70, 9216
    s_mov_b32 s71, 36864
    v_and_b32 v3, 7, v2
    v_lshlrev_b32 v3, 4, v3
    v_lshrrev_b32 v21, 3, v2
    v_mad_u32_u24 v16, v1, s70, v3
    v_mad_u32_u24 v16, v21, s71, v16
    s_mov_b32 s66, 0
    s_mov_b32 s67, 0
    s_mov_b32 s66, 0
    s_and_b32 s70, s7, 7
    s_cmp_lg_u32 s70, 3
    s_cbranch_scc1 L_c_m0
    buffer_load_dwordx4 v[168:171], v16, s[52:55], s66 offen nt
    s_add_u32 s66, s66, 73728
    buffer_load_dwordx4 v[172:175], v16, s[52:55], s66 offen nt
    s_add_u32 s66, s66, 73728
    buffer_load_dwordx4 v[176:179], v16, s[52:55], s66 offen nt
    s_add_u32 s66, s66, 73728
    buffer_load_dwordx4 v[180:183], v16, s[52:55], s66 offen nt
    s_add_u32 s66, s66, 73728
    buffer_load_dwordx4 v[184:187], v16, s[52:55], s66 offen nt
    s_add_u32 s66, s66, 73728
    s_mov_b32 s68, 800000
lw_46:
    ds_read_b32 v20, v247 offset:32
    s_waitcnt lgkmcnt(0)
    v_cmp_le_u32 vcc, 1, v20
    s_cbranch_vccnz lwd_47
    s_sleep 1
    s_sub_u32 s68, s68, 1
    s_cbranch_scc0 lw_46
lwd_47:
    buffer_load_dwordx4 v[188:191], v16, s[52:55], s66 offen nt
    s_add_u32 s66, s66, 73728
    buffer_load_dwordx4 v[192:195], v16, s[52:55], s66 offen nt
    s_add_u32 s66, s66, 73728
    buffer_load_dwordx4 v[196:199], v16, s[52:55], s66 offen nt
    s_add_u32 s66, s66, 73728
    buffer_load_dwordx4 v[200:203], v16, s[52:55], s66 offen nt
    s_add_u32 s66, s66, 73728
    buffer_load_dwordx4 v[204:207], v16, s[52:55], s66 offen nt
    s_add_u32 s66, s66, 73728
    buffer_load_dwordx4 v[208:211], v16, s[52:55], s66 offen nt
    s_add_u32 s66, s66, 73728
    buffer_load_dwordx4 v[212:215], v16, s[52:55], s66 offen nt
    s_add_u32 s66, s66, 73728
    buffer_load_dwordx4 v[216:219], v16, s[52:55], s66 offen nt
    s_add_u32 s66, s66, 73728
    buffer_load_dwordx4 v[220:223], v16, s[52:55], s66 offen nt
    s_add_u32 s66, s66, 73728
    buffer_load_dwordx4 v[224:227], v16, s[52:55], s66 offen nt
    s_add_u32 s66, s66, 73728
    buffer_load_dwordx4 v[228:231], v16, s[52:55], s66 offen nt
    s_add_u32 s66, s66, 73728
    buffer_load_dwordx4 v[232:235], v16, s[52:55], s66 offen nt
    s_add_u32 s66, s66, 73728
    buffer_load_dwordx4 v[236:239], v16, s[52:55], s66 offen nt
    s_add_u32 s66, s66, 73728
    s_branch L_c_m2
L_c_m0:
    s_mov_b32 s68, 800000
lw_48:
    ds_read_b32 v20, v247 offset:32
    s_waitcnt lgkmcnt(0)
    v_cmp_le_u32 vcc, 1, v20
    s_cbranch_vccnz lwd_49
    s_sleep 1
    s_sub_u32 s68, s68, 1
    s_cbranch_scc0 lw_48
lwd_49:
    buffer_load_dwordx4 v[168:171], v16, s[52:55], s66 offen nt
    s_add_u32 s66, s66, 73728
    buffer_load_dwordx4 v[172:175], v16, s[52:55], s66 offen nt
    s_add_u32 s66, s66, 73728
    buffer_load_dwordx4 v[176:179], v16, s[52:55], s66 offen nt
    s_add_u32 s66, s66, 73728
    buffer_load_dwordx4 v[180:183], v16, s[52:55], s66 offen nt
    s_add_u32 s66, s66, 73728
    buffer_load_dwordx4 v[184:187], v16, s[52:55], s66 offen nt
    s_add_u32 s66, s66, 73728
    buffer_load_dwordx4 v[188:191], v16, s[52:55], s66 offen nt
    s_add_u32 s66, s66, 73728
    buffer_load_dwordx4 v[192:195], v16, s[52:55], s66 offen nt
    s_add_u32 s66, s66, 73728
    buffer_load_dwordx4 v[196:199], v16, s[52:55], s66 offen nt
    s_add_u32 s66, s66, 73728
    buffer_load_dwordx4 v[200:203], v16, s[52:55], s66 offen nt
    s_add_u32 s66, s66, 73728
    buffer_load_dwordx4 v[204:207], v16, s[52:55], s66 offen nt
    s_add_u32 s66, s66, 73728
    buffer_load_dwordx4 v[208:211], v16, s[52:55], s66 offen nt
    s_add_u32 s66, s66, 73728
    buffer_load_dwordx4 v[212:215], v16, s[52:55], s66 offen nt
    s_add_u32 s66, s66, 73728
    buffer_load_dwordx4 v[216:219], v16, s[52:55], s66 offen nt
    s_add_u32 s66, s66, 73728
    buffer_load_dwordx4 v[220:223], v16, s[52:55], s66 offen nt
    s_add_u32 s66, s66, 73728
    buffer_load_dwordx4 v[224:227], v16, s[52:55], s66 offen nt
    s_add_u32 s66, s66, 73728
    buffer_load_dwordx4 v[228:231], v16, s[52:55], s66 offen nt
    s_add_u32 s66, s66, 73728
    buffer_load_dwordx4 v[232:235], v16, s[52:55], s66 offen nt
    s_add_u32 s66, s66, 73728
    buffer_load_dwordx4 v[236:239], v16, s[52:55], s66 offen nt
    s_add_u32 s66, s66, 73728
L_c_m2:
    v_mov_b32 v20, 1
    s_mov_b64 exec, 1
    ds_add_u32 v247, v20 offset:20
    s_mov_b64 exec, -1
    v_lshlrev_b32 v18, 4, v0
    v_lshlrev_b32 v19, 2, v0
    s_mul_i32 s70, s3, 144
    v_lshrrev_b32 v20, 3, v2
    v_lshl_add_u32 v20, v20, 2, v1
    v_and_b32 v17, 7, v2
    v_lshl_add_u32 v72, v17, 3, v20
    v_add_lshl_u32 v72, v72, s70, 2
    v_and_b32 v17, 1, v2
    v_lshl_add_u32 v73, v17, 3, v20
    s_add_u32 s70, s70, 128
    v_add_lshl_u32 v73, v73, s70, 2
    v_add_u32 v74, 1024, v72
    v_add_u32 v75, 1024, v73
    v_add_u32 v76, 7680, v72
    v_add_u32 v77, 7680, v73
    v_add_u32 v78, 5376, v72
    v_add_u32 v79, 5376, v73
    s_branch L_mphase
L_m_m:
    v_lshl_add_u32 v14, v2, 2, v1
    s_lshl_b32 s70, s3, 6
    v_add_u32 v15, s70, v14
    v_lshlrev_b32 v3, 1, v15
    global_load_short_d16_hi v24, v3, s[16:17]
    v_lshlrev_b32 v3, 1, v14
    global_load_short_d16_hi v25, v3, s[16:17] offset:1024
    s_lshl_b32 s70, s7, 7
    v_add_u32 v3, s70, v3
    global_load_short_d16_hi v23, v3, s[30:31]
    s_mul_i32 s69, s7, 73728
    s_lshl_b32 s70, s96, 7
    s_add_u32 s69, s69, s70
    s_add_u32 s52, s32, s69
    s_addc_u32 s53, s33, 0
    s_mov_b32 s54, 73728
    s_mov_b32 s55, 0x20000
    s_add_u32 s69, s69, 512
    s_add_u32 s56, s32, s69
    s_addc_u32 s57, s33, 0
    s_mov_b32 s58, 73728
    s_mov_b32 s59, 0x20000
    s_mov_b32 s64, 4608
    s_mov_b32 s70, 1152
    s_mov_b32 s71, 36864
    v_and_b32 v3, 7, v2
    v_lshlrev_b32 v3, 4, v3
    v_lshrrev_b32 v21, 3, v2
    v_mad_u32_u24 v16, v1, s70, v3
    v_mad_u32_u24 v16, v21, s71, v16
    s_mov_b32 s66, 0
    s_mov_b32 s67, 0
    s_mov_b32 s68, 800000
lw_50:
    ds_read_b32 v26, v247 offset:20
    s_waitcnt lgkmcnt(0)
    v_cmp_le_u32 vcc, 4, v26
    s_cbranch_vccnz lwd_51
    s_sleep 1
    s_sub_u32 s68, s68, 1
    s_cbranch_scc0 lw_50
lwd_51:
    s_lshl_b32 s70, s96, 6
    v_add_lshl_u32 v30, v0, s70, 4
    v_min_u32 v31, 31, v0
    v_lshl_add_u32 v31, v31, 4, 0
    v_add_u32 v31, 4096, v31
    s_mov_b32 s50, 43264
    buffer_load_dwordx4 v[32:35], v30, s[60:63], s50 offen sc1
    buffer_load_dwordx4 v[36:39], v31, s[60:63], s50 offen sc1
L_mphase:
    v_lshlrev_b32 v15, 2, v15
    v_lshlrev_b32 v22, 2, v14
    v_mul_u32_u24 v3, 2304, v1
    v_lshl_add_u32 v3, v2, 4, v3
    s_lshl_b32 s70, s3, 8
    s_add_u32 s44, s70, 53248
    s_add_u32 s45, s44, 9216
    s_add_u32 s46, s44, 18432
    s_add_u32 s47, s44, 27648
    s_mov_b32 s48, 40960
    s_mov_b32 s49, 20000
    s_mov_b32 s18, 55296
    s_mov_b32 s19, 64512
    s_mov_b32 s20, 73728
    s_mov_b32 s21, 82944
    buffer_load_dword v27, v15, s[60:63], s48 offen sc1
    buffer_load_dword v28, v22, s[60:63], s48 offen offset:2048 sc1
    v_lshrrev_b32 v21, 1, v1
    s_lshl_b32 s70, s3, 1
    v_add_lshl_u32 v21, v21, s70, 8
    v_and_b32 v17, 7, v2
    v_lshl_add_u32 v21, v17, 5, v21
    v_and_b32 v17, 1, v1
    v_lshl_add_u32 v21, v17, 4, v21
    s_mul_i32 s97, s7, 2304
    s_lshl_b32 s70, s3, 8
    s_add_u32 s97, s97, s70
    s_add_u32 s97, s97, 89088
    s_and_b32 s96, s3, 3
    s_mul_i32 s69, s7, 73728
    s_lshl_b32 s70, s96, 7
    s_add_u32 s69, s69, s70
    s_add_u32 s52, s32, s69
    s_addc_u32 s53, s33, 0
    s_mov_b32 s54, 73728
    s_mov_b32 s55, 0x20000
    s_add_u32 s69, s69, 512
    s_add_u32 s56, s32, s69
    s_addc_u32 s57, s33, 0
    s_mov_b32 s58, 73728
    s_mov_b32 s59, 0x20000
L_gaw:
    s_waitcnt vmcnt(0)
    v_xor_b32 v26, v13, v27
    v_bitop3_b32 v26, v28, v13, v26 bitop3:0xbe
    v_and_b32 v26, 0xff, v26
    v_cmp_ne_u32 vcc, 0, v26
    s_cbranch_vccnz L_gar
L_gad:
    v_and_b32 v27, 0xffff0000, v27
    v_and_b32 v28, 0xffff0000, v28
    s_cmp_lt_u32 s3, 4
    s_cbranch_scc1 L_mbe
L_mbw:
    v_xor_b32 v26, s8, v32
    v_bitop3_b32 v26, v33, s9, v26 bitop3:0xbe
    v_bitop3_b32 v26, v34, s10, v26 bitop3:0xbe
    v_bitop3_b32 v26, v35, s11, v26 bitop3:0xbe
    v_bitop3_b32 v26, v36, s8, v26 bitop3:0xbe
    v_bitop3_b32 v26, v37, s9, v26 bitop3:0xbe
    v_bitop3_b32 v26, v38, s10, v26 bitop3:0xbe
    v_bitop3_b32 v26, v39, s11, v26 bitop3:0xbe
    v_and_b32 v26, 0xff, v26
    v_cmp_ne_u32 vcc, 0, v26
    s_cbranch_vccnz L_mbr
L_mbd:
    v_cmp_le_u32 vcc, 2304, v30
    v_and_b32 v32, 0xffff0000, v32
    v_and_b32 v33, 0xffff0000, v33
    v_and_b32 v34, 0xffff0000, v34
    v_and_b32 v35, 0xffff0000, v35
    v_and_b32 v36, 0xffff0000, v36
    v_and_b32 v37, 0xffff0000, v37
    v_and_b32 v38, 0xffff0000, v38
    v_and_b32 v39, 0xffff0000, v39
    v_add_f32 v36, 1.0, v36
    v_cvt_pk_bf16_f32 v36, v36, v36
    v_lshlrev_b32 v36, 16, v36
    v_add_f32 v37, 1.0, v37
    v_cvt_pk_bf16_f32 v37, v37, v37
    v_lshlrev_b32 v37, 16, v37
    v_add_f32 v38, 1.0, v38
    v_cvt_pk_bf16_f32 v38, v38, v38
    v_lshlrev_b32 v38, 16, v38
    v_add_f32 v39, 1.0, v39
    v_cvt_pk_bf16_f32 v39, v39, v39
    v_lshlrev_b32 v39, 16, v39
    v_add_f32 v29, 1.0, v32
    v_cvt_pk_bf16_f32 v29, v29, v29
    v_lshlrev_b32 v29, 16, v29
    v_cndmask_b32 v32, v32, v29, vcc
    v_add_f32 v29, 1.0, v33
    v_cvt_pk_bf16_f32 v29, v29, v29
    v_lshlrev_b32 v29, 16, v29
    v_cndmask_b32 v33, v33, v29, vcc
    v_add_f32 v29, 1.0, v34
    v_cvt_pk_bf16_f32 v29, v29, v29
    v_lshlrev_b32 v29, 16, v29
    v_cndmask_b32 v34, v34, v29, vcc
    v_add_f32 v29, 1.0, v35
    v_cvt_pk_bf16_f32 v29, v29, v29
    v_lshlrev_b32 v29, 16, v29
    v_cndmask_b32 v35, v35, v29, vcc
    ds_write_b128 v30, v[32:35] offset:5376
    ds_write_b128 v31, v[36:39] offset:5376
    s_waitcnt lgkmcnt(0)
L_mbe:
    s_cmp_lg_u32 s3, 3
    s_cbranch_scc1 L_dn
    v_min_u32 v29, 8, v2
    v_mul_u32_u24 v29, 1152, v29
    s_mul_i32 s70, s4, 18432
    s_add_u32 s70, s70, 524288
    s_mov_b32 s68, 20000
    buffer_load_dwordx4 v[100:103], v29, s[60:63], s70 offen offset:1040 sc1
poll_52:
    s_waitcnt vmcnt(0)
    v_xor_b32 v26, s8, v100
    v_bitop3_b32 v26, v101, s9, v26 bitop3:0xbe
    v_bitop3_b32 v26, v102, s10, v26 bitop3:0xbe
    v_bitop3_b32 v26, v103, s11, v26 bitop3:0xbe
    v_and_b32 v26, 0xff, v26
    v_cmp_ne_u32 vcc, 0, v26
    s_cbranch_vccz ok_54
    s_sub_u32 s68, s68, 1
    s_cbranch_scc1 ok_54
    buffer_load_dwordx4 v[100:103], v29, s[60:63], s70 offen offset:1040 sc1
    s_branch poll_52
ok_54:
pd_53:
L_dn:
    s_barrier
    s_cmp_eq_u32 s3, 0
    s_cbranch_scc1 L_mp0
    s_mov_b32 s68, 20000
    buffer_load_dwordx4 v[104:107], v3, s[60:63], s44 offen sc1
    buffer_load_dwordx4 v[108:111], v3, s[60:63], s45 offen sc1
    buffer_load_dwordx4 v[112:115], v3, s[60:63], s46 offen sc1
    buffer_load_dwordx4 v[116:119], v3, s[60:63], s47 offen sc1
    s_cmp_ge_u32 s3, 4
    s_cbranch_scc1 mbp_58
    ds_read_b128 v[50:53], v18 offset:7680
    ds_read_b128 v[54:57], v18 offset:8704
    ds_read_b32 v58, v19 offset:9728
    ds_read_b32 v59, v247 offset:7680
    ds_read2st64_b32 v[88:89], v76 offset0:0 offset1:1
    ds_read_b32 v90, v77
    ds_read_b128 v[60:63], v18 offset:5376
    ds_read_b128 v[64:67], v18 offset:6400
    ds_read_b32 v68, v19 offset:7424
    ds_read_b32 v69, v247 offset:5376
    ds_read2st64_b32 v[92:93], v78 offset0:0 offset1:1
    ds_read_b32 v94, v79
mbp_58:
poll_55:
    s_waitcnt vmcnt(0)
    v_xor_b32 v26, v245, v104
    v_bitop3_b32 v26, v108, v245, v26 bitop3:0xbe
    v_bitop3_b32 v26, v112, v245, v26 bitop3:0xbe
    v_bitop3_b32 v26, v116, v245, v26 bitop3:0xbe
    v_and_b32 v26, 0xff, v26
    v_cmp_ne_u32 vcc, 0, v26
    s_cbranch_vccz ok_57
    s_sub_u32 s68, s68, 1
    s_cbranch_scc1 ok_57
    buffer_load_dwordx4 v[104:107], v3, s[60:63], s44 offen sc1
    buffer_load_dwordx4 v[108:111], v3, s[60:63], s45 offen sc1
    buffer_load_dwordx4 v[112:115], v3, s[60:63], s46 offen sc1
    buffer_load_dwordx4 v[116:119], v3, s[60:63], s47 offen sc1
    s_branch poll_55
ok_57:
    v_pk_add_f32 v[104:105], v[104:105], v[108:109]
    v_pk_add_f32 v[106:107], v[106:107], v[110:111]
    v_pk_add_f32 v[112:113], v[112:113], v[116:117]
    v_pk_add_f32 v[114:115], v[114:115], v[118:119]
    v_pk_add_f32 v[104:105], v[104:105], v[112:113]
    v_pk_add_f32 v[106:107], v[106:107], v[114:115]
pd_56:
    s_nop 1
    v_permlane32_swap_b32 v104, v106
    v_permlane32_swap_b32 v105, v107
    v_pk_add_f32 v[104:105], v[104:105], v[106:107]
    s_nop 1
    v_permlane16_swap_b32 v104, v105
    v_add_f32 v104, v104, v105
    v_cvt_pk_bf16_f32 v104, v104, v104
    v_lshlrev_b32 v104, 16, v104
    v_mul_f32 v104, v104, v27
    v_cvt_pk_bf16_f32 v104, v104, v104
    v_lshlrev_b32 v104, 16, v104
    v_add_f32 v104, v104, v24
    v_cvt_pk_bf16_f32 v104, v104, v104
    v_lshlrev_b32 v104, 16, v104
L_mp1:
    ds_write_b32 v15, v104 offset:1024
    s_cmp_ge_u32 s3, 4
    s_waitcnt lgkmcnt(0)
    s_barrier
    s_cbranch_scc1 L_mw2
    ds_read_b128 v[40:43], v18 offset:1024
    ds_read_b128 v[44:47], v18 offset:2048
    ds_read_b32 v48, v19 offset:3072
    ds_read_b32 v49, v247 offset:1024
    ds_read2st64_b32 v[84:85], v74 offset0:0 offset1:1
    ds_read_b32 v86, v75
    v_mov_b32 v81, 0x3ae38e39
    s_waitcnt lgkmcnt(2)
    v_pk_add_f32 v[40:41], v[40:41], v[48:49] op_sel:[0,1] op_sel_hi:[1,1] neg_lo:[0,1] neg_hi:[0,1]
    v_pk_add_f32 v[42:43], v[42:43], v[48:49] op_sel:[0,1] op_sel_hi:[1,1] neg_lo:[0,1] neg_hi:[0,1]
    v_pk_add_f32 v[44:45], v[44:45], v[48:49] op_sel:[0,1] op_sel_hi:[1,1] neg_lo:[0,1] neg_hi:[0,1]
    v_pk_add_f32 v[46:47], v[46:47], v[48:49] op_sel:[0,1] op_sel_hi:[1,1] neg_lo:[0,1] neg_hi:[0,1]
    v_sub_f32 v80, v48, v49
    v_pk_add_f32 v[96:97], v[40:41], v[42:43]
    v_pk_mul_f32 v[98:99], v[40:41], v[40:41]
    v_pk_add_f32 v[82:83], v[44:45], v[46:47]
    v_pk_fma_f32 v[98:99], v[42:43], v[42:43], v[98:99]
    v_pk_add_f32 v[96:97], v[96:97], v[82:83]
    v_pk_fma_f32 v[98:99], v[44:45], v[44:45], v[98:99]
    v_add_f32 v96, v96, v80
    v_pk_fma_f32 v[98:99], v[46:47], v[46:47], v[98:99]
    v_add_f32 v96, v96, v97
    v_fmac_f32 v98, v80, v80
    v_add_f32 v98, v98, v99
    v_add_f32_dpp v96, v96, v96 quad_perm:[1,0,3,2] row_mask:0xf bank_mask:0xf
    s_nop 0
    v_add_f32_dpp v98, v98, v98 quad_perm:[1,0,3,2] row_mask:0xf bank_mask:0xf
    v_add_f32_dpp v96, v96, v96 quad_perm:[2,3,0,1] row_mask:0xf bank_mask:0xf
    s_nop 0
    v_add_f32_dpp v98, v98, v98 quad_perm:[2,3,0,1] row_mask:0xf bank_mask:0xf
    v_add_f32_dpp v96, v96, v96 row_half_mirror row_mask:0xf bank_mask:0xf
    s_nop 0
    v_add_f32_dpp v98, v98, v98 row_half_mirror row_mask:0xf bank_mask:0xf
    v_add_f32_dpp v96, v96, v96 row_mirror row_mask:0xf bank_mask:0xf
    s_nop 0
    v_add_f32_dpp v98, v98, v98 row_mirror row_mask:0xf bank_mask:0xf
    v_add_f32_dpp v96, v96, v96 row_bcast:15 row_mask:0xa bank_mask:0xf
    s_nop 0
    v_add_f32_dpp v98, v98, v98 row_bcast:15 row_mask:0xa bank_mask:0xf
    v_add_f32_dpp v96, v96, v96 row_bcast:31 row_mask:0xc bank_mask:0xf
    s_nop 0
    v_add_f32_dpp v98, v98, v98 row_bcast:31 row_mask:0xc bank_mask:0xf
    v_readlane_b32 s70, v96, 63
    v_readlane_b32 s71, v98, 63
    s_nop 0
    v_mul_f32 v96, s70, v81
    v_mul_f32 v98, s71, v81
    v_fma_f32 v98, -v96, v96, v98
    v_max_f32 v98, 0, v98
    v_add_f32 v98, 0x3727c5ac, v98
    v_rsq_f32 v98, v98
    v_add_f32 v97, v96, v49
    s_waitcnt lgkmcnt(0)
    v_pk_add_f32 v[40:41], v[40:41], v[96:97] op_sel_hi:[1,0] neg_lo:[0,1] neg_hi:[0,1]
    v_pk_add_f32 v[42:43], v[42:43], v[96:97] op_sel_hi:[1,0] neg_lo:[0,1] neg_hi:[0,1]
    v_pk_add_f32 v[44:45], v[44:45], v[96:97] op_sel_hi:[1,0] neg_lo:[0,1] neg_hi:[0,1]
    v_pk_add_f32 v[46:47], v[46:47], v[96:97] op_sel_hi:[1,0] neg_lo:[0,1] neg_hi:[0,1]
    v_pk_add_f32 v[48:49], v[48:49], v[96:97] op_sel:[0,1] op_sel_hi:[1,1] neg_lo:[0,1] neg_hi:[0,1]
    v_pk_add_f32 v[84:85], v[84:85], v[96:97] op_sel:[0,1] op_sel_hi:[1,1] neg_lo:[0,1] neg_hi:[0,1]
    v_pk_add_f32 v[86:87], v[86:87], v[96:97] op_sel:[0,1] op_sel_hi:[1,1] neg_lo:[0,1] neg_hi:[0,1]
    v_pk_mul_f32 v[50:51], v[50:51], v[98:99] op_sel_hi:[1,0]
    v_pk_mul_f32 v[52:53], v[52:53], v[98:99] op_sel_hi:[1,0]
    v_pk_mul_f32 v[54:55], v[54:55], v[98:99] op_sel_hi:[1,0]
    v_pk_mul_f32 v[56:57], v[56:57], v[98:99] op_sel_hi:[1,0]
    v_pk_mul_f32 v[58:59], v[58:59], v[98:99] op_sel_hi:[1,0]
    v_pk_mul_f32 v[88:89], v[88:89], v[98:99] op_sel_hi:[1,0]
    v_pk_mul_f32 v[90:91], v[90:91], v[98:99] op_sel_hi:[1,0]
    v_pk_fma_f32 v[40:41], v[40:41], v[50:51], v[60:61]
    v_pk_fma_f32 v[42:43], v[42:43], v[52:53], v[62:63]
    v_pk_fma_f32 v[44:45], v[44:45], v[54:55], v[64:65]
    v_pk_fma_f32 v[46:47], v[46:47], v[56:57], v[66:67]
    v_pk_fma_f32 v[48:49], v[48:49], v[58:59], v[68:69]
    v_pk_fma_f32 v[84:85], v[84:85], v[88:89], v[92:93]
    v_pk_fma_f32 v[86:87], v[86:87], v[90:91], v[94:95]
    v_pk_add_f32 v[40:41], v[40:41], v[48:49] op_sel:[0,1] op_sel_hi:[1,1] neg_lo:[0,1] neg_hi:[0,1]
    v_pk_add_f32 v[42:43], v[42:43], v[48:49] op_sel:[0,1] op_sel_hi:[1,1] neg_lo:[0,1] neg_hi:[0,1]
    v_pk_add_f32 v[44:45], v[44:45], v[48:49] op_sel:[0,1] op_sel_hi:[1,1] neg_lo:[0,1] neg_hi:[0,1]
    v_pk_add_f32 v[46:47], v[46:47], v[48:49] op_sel:[0,1] op_sel_hi:[1,1] neg_lo:[0,1] neg_hi:[0,1]
    v_sub_f32 v80, v48, v49
    v_pk_add_f32 v[96:97], v[40:41], v[42:43]
    v_pk_mul_f32 v[98:99], v[40:41], v[40:41]
    v_pk_add_f32 v[82:83], v[44:45], v[46:47]
    v_pk_fma_f32 v[98:99], v[42:43], v[42:43], v[98:99]
    v_pk_add_f32 v[96:97], v[96:97], v[82:83]
    v_pk_fma_f32 v[98:99], v[44:45], v[44:45], v[98:99]
    v_add_f32 v96, v96, v80
    v_pk_fma_f32 v[98:99], v[46:47], v[46:47], v[98:99]
    v_add_f32 v96, v96, v97
    v_fmac_f32 v98, v80, v80
    v_add_f32 v98, v98, v99
    v_add_f32_dpp v96, v96, v96 quad_perm:[1,0,3,2] row_mask:0xf bank_mask:0xf
    s_nop 0
    v_add_f32_dpp v98, v98, v98 quad_perm:[1,0,3,2] row_mask:0xf bank_mask:0xf
    v_add_f32_dpp v96, v96, v96 quad_perm:[2,3,0,1] row_mask:0xf bank_mask:0xf
    s_nop 0
    v_add_f32_dpp v98, v98, v98 quad_perm:[2,3,0,1] row_mask:0xf bank_mask:0xf
    v_add_f32_dpp v96, v96, v96 row_half_mirror row_mask:0xf bank_mask:0xf
    s_nop 0
    v_add_f32_dpp v98, v98, v98 row_half_mirror row_mask:0xf bank_mask:0xf
    v_add_f32_dpp v96, v96, v96 row_mirror row_mask:0xf bank_mask:0xf
    s_nop 0
    v_add_f32_dpp v98, v98, v98 row_mirror row_mask:0xf bank_mask:0xf
    v_add_f32_dpp v96, v96, v96 row_bcast:15 row_mask:0xa bank_mask:0xf
    s_nop 0
    v_add_f32_dpp v98, v98, v98 row_bcast:15 row_mask:0xa bank_mask:0xf
    v_add_f32_dpp v96, v96, v96 row_bcast:31 row_mask:0xc bank_mask:0xf
    s_nop 0
    v_add_f32_dpp v98, v98, v98 row_bcast:31 row_mask:0xc bank_mask:0xf
    v_readlane_b32 s70, v96, 63
    v_readlane_b32 s71, v98, 63
    s_nop 0
    v_mul_f32 v96, s70, v81
    v_mul_f32 v98, s71, v81
    v_fma_f32 v98, -v96, v96, v98
    v_max_f32 v98, 0, v98
    v_add_f32 v98, 0x3727c5ac, v98
    v_rsq_f32 v98, v98
    v_add_f32 v97, v96, v49
    v_pk_add_f32 v[84:85], v[84:85], v[96:97] op_sel:[0,1] op_sel_hi:[1,1] neg_lo:[0,1] neg_hi:[0,1]
    v_pk_add_f32 v[86:87], v[86:87], v[96:97] op_sel:[0,1] op_sel_hi:[1,1] neg_lo:[0,1] neg_hi:[0,1]
    v_pk_mul_f32 v[84:85], v[84:85], v[98:99] op_sel_hi:[1,0]
    v_pk_mul_f32 v[86:87], v[86:87], v[98:99] op_sel_hi:[1,0]
    v_cvt_pk_bf16_f32 v84, v84, v84
    v_cvt_pk_bf16_f32 v85, v85, v85
    v_cvt_pk_bf16_f32 v86, v86, v86
    v_mov_b32_dpp v88, v84 row_half_mirror row_mask:0xf bank_mask:0xf
    v_mov_b32_dpp v89, v85 row_half_mirror row_mask:0xf bank_mask:0xf
    v_mov_b32_dpp v90, v86 row_half_mirror row_mask:0xf bank_mask:0xf
    v_and_b32_dpp v40, v84, v4 quad_perm:[0,0,0,0] row_mask:0xf bank_mask:0xf
    v_and_b32_dpp v41, v84, v5 quad_perm:[0,0,0,0] row_mask:0xf bank_mask:0xf
    v_and_b32_dpp v42, v88, v6 quad_perm:[3,3,3,3] row_mask:0xf bank_mask:0xf
    v_and_b32_dpp v43, v88, v7 quad_perm:[3,3,3,3] row_mask:0xf bank_mask:0xf
    v_and_b32_dpp v44, v84, v4 quad_perm:[1,1,1,1] row_mask:0xf bank_mask:0xf
    v_and_b32_dpp v45, v84, v5 quad_perm:[1,1,1,1] row_mask:0xf bank_mask:0xf
    v_and_b32_dpp v46, v88, v6 quad_perm:[2,2,2,2] row_mask:0xf bank_mask:0xf
    v_and_b32_dpp v47, v88, v7 quad_perm:[2,2,2,2] row_mask:0xf bank_mask:0xf
    v_mfma_f32_16x16x32_bf16 v[240:243], v[40:43], v[168:171], 0
    v_and_b32_dpp v48, v84, v4 quad_perm:[2,2,2,2] row_mask:0xf bank_mask:0xf
    v_and_b32_dpp v49, v84, v5 quad_perm:[2,2,2,2] row_mask:0xf bank_mask:0xf
    v_and_b32_dpp v50, v88, v6 quad_perm:[1,1,1,1] row_mask:0xf bank_mask:0xf
    v_and_b32_dpp v51, v88, v7 quad_perm:[1,1,1,1] row_mask:0xf bank_mask:0xf
    v_mfma_f32_16x16x32_bf16 v[240:243], v[44:47], v[172:175], v[240:243]
    v_and_b32_dpp v40, v84, v4 quad_perm:[3,3,3,3] row_mask:0xf bank_mask:0xf
    v_and_b32_dpp v41, v84, v5 quad_perm:[3,3,3,3] row_mask:0xf bank_mask:0xf
    v_and_b32_dpp v42, v88, v6 quad_perm:[0,0,0,0] row_mask:0xf bank_mask:0xf
    v_and_b32_dpp v43, v88, v7 quad_perm:[0,0,0,0] row_mask:0xf bank_mask:0xf
    v_mfma_f32_16x16x32_bf16 v[240:243], v[48:51], v[176:179], v[240:243]
    v_and_b32_dpp v44, v88, v4 quad_perm:[3,3,3,3] row_mask:0xf bank_mask:0xf
    v_and_b32_dpp v45, v88, v5 quad_perm:[3,3,3,3] row_mask:0xf bank_mask:0xf
    v_and_b32_dpp v46, v84, v6 quad_perm:[0,0,0,0] row_mask:0xf bank_mask:0xf
    v_and_b32_dpp v47, v84, v7 quad_perm:[0,0,0,0] row_mask:0xf bank_mask:0xf
    v_mfma_f32_16x16x32_bf16 v[240:243], v[40:43], v[180:183], v[240:243]
    v_and_b32_dpp v48, v88, v4 quad_perm:[2,2,2,2] row_mask:0xf bank_mask:0xf
    v_and_b32_dpp v49, v88, v5 quad_perm:[2,2,2,2] row_mask:0xf bank_mask:0xf
    v_and_b32_dpp v50, v84, v6 quad_perm:[1,1,1,1] row_mask:0xf bank_mask:0xf
    v_and_b32_dpp v51, v84, v7 quad_perm:[1,1,1,1] row_mask:0xf bank_mask:0xf
    v_mfma_f32_16x16x32_bf16 v[240:243], v[44:47], v[184:187], v[240:243]
    v_and_b32_dpp v40, v88, v4 quad_perm:[1,1,1,1] row_mask:0xf bank_mask:0xf
    v_and_b32_dpp v41, v88, v5 quad_perm:[1,1,1,1] row_mask:0xf bank_mask:0xf
    v_and_b32_dpp v42, v84, v6 quad_perm:[2,2,2,2] row_mask:0xf bank_mask:0xf
    v_and_b32_dpp v43, v84, v7 quad_perm:[2,2,2,2] row_mask:0xf bank_mask:0xf
    v_mfma_f32_16x16x32_bf16 v[240:243], v[48:51], v[188:191], v[240:243]
    v_and_b32_dpp v44, v88, v4 quad_perm:[0,0,0,0] row_mask:0xf bank_mask:0xf
    v_and_b32_dpp v45, v88, v5 quad_perm:[0,0,0,0] row_mask:0xf bank_mask:0xf
    v_and_b32_dpp v46, v84, v6 quad_perm:[3,3,3,3] row_mask:0xf bank_mask:0xf
    v_and_b32_dpp v47, v84, v7 quad_perm:[3,3,3,3] row_mask:0xf bank_mask:0xf
    v_mfma_f32_16x16x32_bf16 v[240:243], v[40:43], v[192:195], v[240:243]
    v_and_b32_dpp v48, v85, v4 quad_perm:[0,0,0,0] row_mask:0xf bank_mask:0xf
    v_and_b32_dpp v49, v85, v5 quad_perm:[0,0,0,0] row_mask:0xf bank_mask:0xf
    v_and_b32_dpp v50, v89, v6 quad_perm:[3,3,3,3] row_mask:0xf bank_mask:0xf
    v_and_b32_dpp v51, v89, v7 quad_perm:[3,3,3,3] row_mask:0xf bank_mask:0xf
    v_mfma_f32_16x16x32_bf16 v[240:243], v[44:47], v[196:199], v[240:243]
    v_and_b32_dpp v40, v85, v4 quad_perm:[1,1,1,1] row_mask:0xf bank_mask:0xf
    v_and_b32_dpp v41, v85, v5 quad_perm:[1,1,1,1] row_mask:0xf bank_mask:0xf
    v_and_b32_dpp v42, v89, v6 quad_perm:[2,2,2,2] row_mask:0xf bank_mask:0xf
    v_and_b32_dpp v43, v89, v7 quad_perm:[2,2,2,2] row_mask:0xf bank_mask:0xf
    v_mfma_f32_16x16x32_bf16 v[240:243], v[48:51], v[200:203], v[240:243]
    v_and_b32_dpp v44, v85, v4 quad_perm:[2,2,2,2] row_mask:0xf bank_mask:0xf
    v_and_b32_dpp v45, v85, v5 quad_perm:[2,2,2,2] row_mask:0xf bank_mask:0xf
    v_and_b32_dpp v46, v89, v6 quad_perm:[1,1,1,1] row_mask:0xf bank_mask:0xf
    v_and_b32_dpp v47, v89, v7 quad_perm:[1,1,1,1] row_mask:0xf bank_mask:0xf
    v_mfma_f32_16x16x32_bf16 v[240:243], v[40:43], v[204:207], v[240:243]
    v_and_b32_dpp v48, v85, v4 quad_perm:[3,3,3,3] row_mask:0xf bank_mask:0xf
    v_and_b32_dpp v49, v85, v5 quad_perm:[3,3,3,3] row_mask:0xf bank_mask:0xf
    v_and_b32_dpp v50, v89, v6 quad_perm:[0,0,0,0] row_mask:0xf bank_mask:0xf
    v_and_b32_dpp v51, v89, v7 quad_perm:[0,0,0,0] row_mask:0xf bank_mask:0xf
    v_mfma_f32_16x16x32_bf16 v[240:243], v[44:47], v[208:211], v[240:243]
    v_and_b32_dpp v40, v89, v4 quad_perm:[3,3,3,3] row_mask:0xf bank_mask:0xf
    v_and_b32_dpp v41, v89, v5 quad_perm:[3,3,3,3] row_mask:0xf bank_mask:0xf
    v_and_b32_dpp v42, v85, v6 quad_perm:[0,0,0,0] row_mask:0xf bank_mask:0xf
    v_and_b32_dpp v43, v85, v7 quad_perm:[0,0,0,0] row_mask:0xf bank_mask:0xf
    v_mfma_f32_16x16x32_bf16 v[240:243], v[48:51], v[212:215], v[240:243]
    v_and_b32_dpp v44, v89, v4 quad_perm:[2,2,2,2] row_mask:0xf bank_mask:0xf
    v_and_b32_dpp v45, v89, v5 quad_perm:[2,2,2,2] row_mask:0xf bank_mask:0xf
    v_and_b32_dpp v46, v85, v6 quad_perm:[1,1,1,1] row_mask:0xf bank_mask:0xf
    v_and_b32_dpp v47, v85, v7 quad_perm:[1,1,1,1] row_mask:0xf bank_mask:0xf
    v_mfma_f32_16x16x32_bf16 v[240:243], v[40:43], v[216:219], v[240:243]
    v_and_b32_dpp v48, v89, v4 quad_perm:[1,1,1,1] row_mask:0xf bank_mask:0xf
    v_and_b32_dpp v49, v89, v5 quad_perm:[1,1,1,1] row_mask:0xf bank_mask:0xf
    v_and_b32_dpp v50, v85, v6 quad_perm:[2,2,2,2] row_mask:0xf bank_mask:0xf
    v_and_b32_dpp v51, v85, v7 quad_perm:[2,2,2,2] row_mask:0xf bank_mask:0xf
    v_mfma_f32_16x16x32_bf16 v[240:243], v[44:47], v[220:223], v[240:243]
    v_and_b32_dpp v40, v89, v4 quad_perm:[0,0,0,0] row_mask:0xf bank_mask:0xf
    v_and_b32_dpp v41, v89, v5 quad_perm:[0,0,0,0] row_mask:0xf bank_mask:0xf
    v_and_b32_dpp v42, v85, v6 quad_perm:[3,3,3,3] row_mask:0xf bank_mask:0xf
    v_and_b32_dpp v43, v85, v7 quad_perm:[3,3,3,3] row_mask:0xf bank_mask:0xf
    v_mfma_f32_16x16x32_bf16 v[240:243], v[48:51], v[224:227], v[240:243]
    v_and_b32_dpp v44, v86, v4 quad_perm:[0,0,0,0] row_mask:0xf bank_mask:0xf
    v_and_b32_dpp v45, v86, v5 quad_perm:[0,0,0,0] row_mask:0xf bank_mask:0xf
    v_and_b32_dpp v46, v90, v6 quad_perm:[3,3,3,3] row_mask:0xf bank_mask:0xf
    v_and_b32_dpp v47, v90, v7 quad_perm:[3,3,3,3] row_mask:0xf bank_mask:0xf
    v_mfma_f32_16x16x32_bf16 v[240:243], v[40:43], v[228:231], v[240:243]
    v_and_b32_dpp v48, v86, v4 quad_perm:[1,1,1,1] row_mask:0xf bank_mask:0xf
    v_and_b32_dpp v49, v86, v5 quad_perm:[1,1,1,1] row_mask:0xf bank_mask:0xf
    v_and_b32_dpp v50, v90, v6 quad_perm:[2,2,2,2] row_mask:0xf bank_mask:0xf
    v_and_b32_dpp v51, v90, v7 quad_perm:[2,2,2,2] row_mask:0xf bank_mask:0xf
    v_mfma_f32_16x16x32_bf16 v[240:243], v[44:47], v[232:235], v[240:243]
    s_nop 0
    v_mfma_f32_16x16x32_bf16 v[240:243], v[48:51], v[236:239], v[240:243]
    s_mov_b32 exec_lo, 0x00ff00ff
    s_mov_b32 exec_hi, 0xff00ff00
    s_nop 5
    ds_write_b128 v21, v[240:243] offset:3328
    s_waitcnt lgkmcnt(0)
    s_barrier
    s_endpgm
L_mp0:
    s_mov_b32 s68, 20000
    buffer_load_dwordx4 v[104:107], v3, s[60:63], s44 offen sc1
    buffer_load_dwordx4 v[108:111], v3, s[60:63], s45 offen sc1
    buffer_load_dwordx4 v[112:115], v3, s[60:63], s46 offen sc1
    buffer_load_dwordx4 v[116:119], v3, s[60:63], s47 offen sc1
    buffer_load_dwordx4 v[120:123], v3, s[60:63], s18 offen sc1
    buffer_load_dwordx4 v[124:127], v3, s[60:63], s19 offen sc1
    buffer_load_dwordx4 v[128:131], v3, s[60:63], s20 offen sc1
    buffer_load_dwordx4 v[132:135], v3, s[60:63], s21 offen sc1
    s_cmp_ge_u32 s3, 4
    s_cbranch_scc1 mbp_62
    ds_read_b128 v[50:53], v18 offset:7680
    ds_read_b128 v[54:57], v18 offset:8704
    ds_read_b32 v58, v19 offset:9728
    ds_read_b32 v59, v247 offset:7680
    ds_read2st64_b32 v[88:89], v76 offset0:0 offset1:1
    ds_read_b32 v90, v77
    ds_read_b128 v[60:63], v18 offset:5376
    ds_read_b128 v[64:67], v18 offset:6400
    ds_read_b32 v68, v19 offset:7424
    ds_read_b32 v69, v247 offset:5376
    ds_read2st64_b32 v[92:93], v78 offset0:0 offset1:1
    ds_read_b32 v94, v79
mbp_62:
poll_59:
    s_waitcnt vmcnt(0)
    v_xor_b32 v26, v245, v104
    v_bitop3_b32 v26, v108, v245, v26 bitop3:0xbe
    v_bitop3_b32 v26, v112, v245, v26 bitop3:0xbe
    v_bitop3_b32 v26, v116, v245, v26 bitop3:0xbe
    v_bitop3_b32 v26, v120, v245, v26 bitop3:0xbe
    v_bitop3_b32 v26, v124, v245, v26 bitop3:0xbe
    v_bitop3_b32 v26, v128, v245, v26 bitop3:0xbe
    v_bitop3_b32 v26, v132, v245, v26 bitop3:0xbe
    v_and_b32 v26, 0xff, v26
    v_cmp_ne_u32 vcc, 0, v26
    s_cbranch_vccz ok_61
    s_sub_u32 s68, s68, 1
    s_cbranch_scc1 ok_61
    buffer_load_dwordx4 v[104:107], v3, s[60:63], s44 offen sc1
    buffer_load_dwordx4 v[108:111], v3, s[60:63], s45 offen sc1
    buffer_load_dwordx4 v[112:115], v3, s[60:63], s46 offen sc1
    buffer_load_dwordx4 v[116:119], v3, s[60:63], s47 offen sc1
    buffer_load_dwordx4 v[120:123], v3, s[60:63], s18 offen sc1
    buffer_load_dwordx4 v[124:127], v3, s[60:63], s19 offen sc1
    buffer_load_dwordx4 v[128:131], v3, s[60:63], s20 offen sc1
    buffer_load_dwordx4 v[132:135], v3, s[60:63], s21 offen sc1
    s_branch poll_59
ok_61:
    v_pk_add_f32 v[104:105], v[104:105], v[108:109]
    v_pk_add_f32 v[106:107], v[106:107], v[110:111]
    v_pk_add_f32 v[112:113], v[112:113], v[116:117]
    v_pk_add_f32 v[114:115], v[114:115], v[118:119]
    v_pk_add_f32 v[104:105], v[104:105], v[112:113]
    v_pk_add_f32 v[106:107], v[106:107], v[114:115]
    v_pk_add_f32 v[120:121], v[120:121], v[124:125]
    v_pk_add_f32 v[122:123], v[122:123], v[126:127]
    v_pk_add_f32 v[128:129], v[128:129], v[132:133]
    v_pk_add_f32 v[130:131], v[130:131], v[134:135]
    v_pk_add_f32 v[120:121], v[120:121], v[128:129]
    v_pk_add_f32 v[122:123], v[122:123], v[130:131]
pd_60:
    v_permlane32_swap_b32 v104, v106
    v_permlane32_swap_b32 v105, v107
    v_permlane32_swap_b32 v120, v122
    v_permlane32_swap_b32 v121, v123
    v_pk_add_f32 v[104:105], v[104:105], v[106:107]
    v_pk_add_f32 v[120:121], v[120:121], v[122:123]
    s_nop 0
    v_permlane16_swap_b32 v104, v105
    v_permlane16_swap_b32 v120, v121
    v_add_f32 v104, v104, v105
    v_add_f32 v120, v120, v121
    v_cvt_pk_bf16_f32 v104, v104, v104
    v_lshlrev_b32 v104, 16, v104
    v_mul_f32 v104, v104, v27
    v_cvt_pk_bf16_f32 v104, v104, v104
    v_lshlrev_b32 v104, 16, v104
    v_add_f32 v104, v104, v24
    v_cvt_pk_bf16_f32 v104, v104, v104
    v_lshlrev_b32 v104, 16, v104
    v_cvt_pk_bf16_f32 v120, v120, v120
    v_lshlrev_b32 v120, 16, v120
    v_mul_f32 v120, v120, v28
    v_cvt_pk_bf16_f32 v120, v120, v120
    v_lshlrev_b32 v120, 16, v120
    v_add_f32 v120, v120, v25
    v_cvt_pk_bf16_f32 v120, v120, v120
    v_lshlrev_b32 v120, 16, v120
    ds_write_b32 v22, v120 offset:3072
    s_branch L_mp1
L_mw2:
    s_lshl_b32 s23, s4, 4
    s_add_u32 s23, s23, s5
    s_mul_i32 s23, s23, 1152
    s_add_u32 s23, s23, 524288
    v_mov_b32 v100, s8
    v_mov_b32 v101, s9
    v_mov_b32 v102, s10
    v_mov_b32 v103, s11
    s_cmp_lg_u32 s5, 9
    s_cbranch_scc1 L_f1
    s_cmp_lg_u32 s3, 5
    s_cbranch_scc1 L_f1
    s_mov_b64 exec, 1
    s_cmp_eq_u32 s27, 2
    s_cbranch_scc0 ps_63
    buffer_store_dwordx4 v[100:103], v247, s[60:63], s23 offen offset:1056
pe_64:
L_f1:
    s_mov_b64 exec, -1
    buffer_load_dwordx4 v[168:171], v16, s[52:55], s66 offen
    s_add_u32 s66, s66, s64
    buffer_load_dwordx4 v[172:175], v16, s[52:55], s66 offen
    s_add_u32 s66, s66, s64
    buffer_load_dwordx4 v[176:179], v16, s[52:55], s66 offen
    s_add_u32 s66, s66, s64
    buffer_load_dwordx4 v[180:183], v16, s[52:55], s66 offen
    s_add_u32 s66, s66, s64
    buffer_load_dwordx4 v[184:187], v16, s[52:55], s66 offen
    s_add_u32 s66, s66, s64
    buffer_load_dwordx4 v[188:191], v16, s[52:55], s66 offen
    s_add_u32 s66, s66, s64
    buffer_load_dwordx4 v[192:195], v16, s[52:55], s66 offen
    s_add_u32 s66, s66, s64
    buffer_load_dwordx4 v[196:199], v16, s[52:55], s66 offen
    s_add_u32 s66, s66, s64
    buffer_load_dwordx4 v[200:203], v16, s[56:59], s67 offen
    s_add_u32 s67, s67, s64
    buffer_load_dwordx4 v[204:207], v16, s[56:59], s67 offen
    s_add_u32 s67, s67, s64
    buffer_load_dwordx4 v[208:211], v16, s[56:59], s67 offen
    s_add_u32 s67, s67, s64
    buffer_load_dwordx4 v[212:215], v16, s[56:59], s67 offen
    s_add_u32 s67, s67, s64
    buffer_load_dwordx4 v[216:219], v16, s[56:59], s67 offen
    s_add_u32 s67, s67, s64
    buffer_load_dwordx4 v[220:223], v16, s[56:59], s67 offen
    s_add_u32 s67, s67, s64
    buffer_load_dwordx4 v[224:227], v16, s[56:59], s67 offen
    s_add_u32 s67, s67, s64
    buffer_load_dwordx4 v[228:231], v16, s[56:59], s67 offen
    s_add_u32 s67, s67, s64
L_mw2a:
    s_cmp_lg_u32 s96, 0
    s_cbranch_scc1 L_mw2b
    s_mov_b32 s66, 1024
    buffer_load_dwordx4 v[40:43], v16, s[52:55], s66 offen nt
    s_add_u32 s66, s66, s64
    buffer_load_dwordx4 v[44:47], v16, s[52:55], s66 offen nt
    s_add_u32 s66, s66, s64
    buffer_load_dwordx4 v[48:51], v16, s[52:55], s66 offen nt
    s_add_u32 s66, s66, s64
    buffer_load_dwordx4 v[52:55], v16, s[52:55], s66 offen nt
    s_add_u32 s66, s66, s64
    buffer_load_dwordx4 v[56:59], v16, s[52:55], s66 offen nt
    s_add_u32 s66, s66, s64
    buffer_load_dwordx4 v[60:63], v16, s[52:55], s66 offen nt
    s_add_u32 s66, s66, s64
    buffer_load_dwordx4 v[64:67], v16, s[52:55], s66 offen nt
    s_add_u32 s66, s66, s64
    buffer_load_dwordx4 v[68:71], v16, s[52:55], s66 offen nt
    s_add_u32 s66, s66, s64
L_mw2b:
    v_add_u32 v22, 3328, v22
    v_mov_b32 v82, 0xc0135761
    s_cmp_eq_u32 s96, 0
    s_barrier
    ds_read2st64_b32 v[72:73], v22 offset0:0 offset1:1
    ds_read2st64_b32 v[74:75], v22 offset0:2 offset1:3
    ds_read2st64_b32 v[76:77], v22 offset0:4 offset1:5
    ds_read2st64_b32 v[78:79], v22 offset0:6 offset1:7
    s_waitcnt lgkmcnt(2)
    v_pk_add_f32 v[72:73], v[72:73], v[74:75]
    s_waitcnt lgkmcnt(0)
    v_pk_add_f32 v[76:77], v[76:77], v[78:79]
    v_pk_add_f32 v[72:73], v[72:73], v[76:77]
    v_add_f32 v80, v72, v73
    v_cvt_pk_bf16_f32 v80, v80, v80
    v_lshlrev_b32 v80, 16, v80
    v_add_f32 v80, v80, v23
    v_cvt_pk_bf16_f32 v80, v80, v80
    v_lshlrev_b32 v80, 16, v80
    v_mul_f32 v81, v80, v80
    v_fmac_f32 v82, 0xbdd2d3e8, v81
    v_mul_f32 v81, v82, v80
    v_exp_f32 v81, v81
    s_nop 0
    v_add_f32 v81, 1.0, v81
    v_rcp_f32 v81, v81
    s_nop 0
    v_mul_f32 v80, v80, v81
    v_cvt_pk_bf16_f32 v80, v80, v80
    s_nop 1
    v_mov_b32_dpp v81, v80 row_half_mirror row_mask:0xf bank_mask:0xf
    s_waitcnt vmcnt(0)
    s_cbranch_scc1 L_w2_0
    v_and_b32_dpp v84, v80, v4 quad_perm:[0,0,0,0] row_mask:0xf bank_mask:0xf
    v_and_b32_dpp v85, v80, v5 quad_perm:[0,0,0,0] row_mask:0xf bank_mask:0xf
    v_and_b32_dpp v86, v81, v6 quad_perm:[3,3,3,3] row_mask:0xf bank_mask:0xf
    v_and_b32_dpp v87, v81, v7 quad_perm:[3,3,3,3] row_mask:0xf bank_mask:0xf
    v_and_b32_dpp v88, v80, v4 quad_perm:[1,1,1,1] row_mask:0xf bank_mask:0xf
    v_and_b32_dpp v89, v80, v5 quad_perm:[1,1,1,1] row_mask:0xf bank_mask:0xf
    v_and_b32_dpp v90, v81, v6 quad_perm:[2,2,2,2] row_mask:0xf bank_mask:0xf
    v_and_b32_dpp v91, v81, v7 quad_perm:[2,2,2,2] row_mask:0xf bank_mask:0xf
    v_mfma_f32_16x16x32_bf16 v[240:243], v[84:87], v[168:171], 0
    v_mfma_f32_16x16x32_bf16 v[232:235], v[84:87], v[200:203], 0
    v_and_b32_dpp v92, v80, v4 quad_perm:[2,2,2,2] row_mask:0xf bank_mask:0xf
    v_and_b32_dpp v93, v80, v5 quad_perm:[2,2,2,2] row_mask:0xf bank_mask:0xf
    v_and_b32_dpp v94, v81, v6 quad_perm:[1,1,1,1] row_mask:0xf bank_mask:0xf
    v_and_b32_dpp v95, v81, v7 quad_perm:[1,1,1,1] row_mask:0xf bank_mask:0xf
    v_mfma_f32_16x16x32_bf16 v[240:243], v[88:91], v[172:175], v[240:243]
    v_mfma_f32_16x16x32_bf16 v[232:235], v[88:91], v[204:207], v[232:235]
    v_and_b32_dpp v84, v80, v4 quad_perm:[3,3,3,3] row_mask:0xf bank_mask:0xf
    v_and_b32_dpp v85, v80, v5 quad_perm:[3,3,3,3] row_mask:0xf bank_mask:0xf
    v_and_b32_dpp v86, v81, v6 quad_perm:[0,0,0,0] row_mask:0xf bank_mask:0xf
    v_and_b32_dpp v87, v81, v7 quad_perm:[0,0,0,0] row_mask:0xf bank_mask:0xf
    v_mfma_f32_16x16x32_bf16 v[240:243], v[92:95], v[176:179], v[240:243]
    v_mfma_f32_16x16x32_bf16 v[232:235], v[92:95], v[208:211], v[232:235]
    v_and_b32_dpp v88, v81, v4 quad_perm:[3,3,3,3] row_mask:0xf bank_mask:0xf
    v_and_b32_dpp v89, v81, v5 quad_perm:[3,3,3,3] row_mask:0xf bank_mask:0xf
    v_and_b32_dpp v90, v80, v6 quad_perm:[0,0,0,0] row_mask:0xf bank_mask:0xf
    v_and_b32_dpp v91, v80, v7 quad_perm:[0,0,0,0] row_mask:0xf bank_mask:0xf
    v_mfma_f32_16x16x32_bf16 v[240:243], v[84:87], v[180:183], v[240:243]
    v_mfma_f32_16x16x32_bf16 v[232:235], v[84:87], v[212:215], v[232:235]
    v_and_b32_dpp v92, v81, v4 quad_perm:[2,2,2,2] row_mask:0xf bank_mask:0xf
    v_and_b32_dpp v93, v81, v5 quad_perm:[2,2,2,2] row_mask:0xf bank_mask:0xf
    v_and_b32_dpp v94, v80, v6 quad_perm:[1,1,1,1] row_mask:0xf bank_mask:0xf
    v_and_b32_dpp v95, v80, v7 quad_perm:[1,1,1,1] row_mask:0xf bank_mask:0xf
    v_mfma_f32_16x16x32_bf16 v[240:243], v[88:91], v[184:187], v[240:243]
    v_mfma_f32_16x16x32_bf16 v[232:235], v[88:91], v[216:219], v[232:235]
    v_and_b32_dpp v84, v81, v4 quad_perm:[1,1,1,1] row_mask:0xf bank_mask:0xf
    v_and_b32_dpp v85, v81, v5 quad_perm:[1,1,1,1] row_mask:0xf bank_mask:0xf
    v_and_b32_dpp v86, v80, v6 quad_perm:[2,2,2,2] row_mask:0xf bank_mask:0xf
    v_and_b32_dpp v87, v80, v7 quad_perm:[2,2,2,2] row_mask:0xf bank_mask:0xf
    v_mfma_f32_16x16x32_bf16 v[240:243], v[92:95], v[188:191], v[240:243]
    v_mfma_f32_16x16x32_bf16 v[232:235], v[92:95], v[220:223], v[232:235]
    v_and_b32_dpp v88, v81, v4 quad_perm:[0,0,0,0] row_mask:0xf bank_mask:0xf
    v_and_b32_dpp v89, v81, v5 quad_perm:[0,0,0,0] row_mask:0xf bank_mask:0xf
    v_and_b32_dpp v90, v80, v6 quad_perm:[3,3,3,3] row_mask:0xf bank_mask:0xf
    v_and_b32_dpp v91, v80, v7 quad_perm:[3,3,3,3] row_mask:0xf bank_mask:0xf
    v_mfma_f32_16x16x32_bf16 v[240:243], v[84:87], v[192:195], v[240:243]
    v_mfma_f32_16x16x32_bf16 v[232:235], v[84:87], v[224:227], v[232:235]
    v_mfma_f32_16x16x32_bf16 v[240:243], v[88:91], v[196:199], v[240:243]
    v_mfma_f32_16x16x32_bf16 v[232:235], v[88:91], v[228:231], v[232:235]
    s_nop 6
    v_permlane32_swap_b32 v240, v84
    v_permlane32_swap_b32 v241, v85
    v_permlane32_swap_b32 v242, v86
    v_permlane32_swap_b32 v243, v87
    v_permlane32_swap_b32 v232, v88
    v_permlane32_swap_b32 v233, v89
    v_permlane32_swap_b32 v234, v90
    v_permlane32_swap_b32 v235, v91
    v_add_f32_dpp v240, v84, v240 row_ror:8 row_mask:0xf bank_mask:0xf
    v_add_f32_dpp v241, v85, v241 row_ror:8 row_mask:0xf bank_mask:0xf
    v_add_f32_dpp v242, v86, v242 row_ror:8 row_mask:0xf bank_mask:0xf
    v_add_f32_dpp v243, v87, v243 row_ror:8 row_mask:0xf bank_mask:0xf
    v_add_f32_dpp v232, v88, v232 row_ror:8 row_mask:0xf bank_mask:0xf
    v_add_f32_dpp v233, v89, v233 row_ror:8 row_mask:0xf bank_mask:0xf
    v_add_f32_dpp v234, v90, v234 row_ror:8 row_mask:0xf bank_mask:0xf
    v_add_f32_dpp v235, v91, v235 row_ror:8 row_mask:0xf bank_mask:0xf
L_w2_1:
    s_mov_b64 exec, 0x00ff00ff
    v_perm_b32 v240, v240, v244, s12
    v_perm_b32 v232, v232, v244, s12
    buffer_store_dwordx4 v[240:243], v246, s[60:63], s97 offen sc1
    buffer_store_dwordx4 v[232:235], v246, s[60:63], s97 offen offset:1024 sc1
    s_cmp_lg_u32 s5, 9
    s_cbranch_scc1 L_f2
    s_cmp_lg_u32 s3, 5
    s_cbranch_scc1 L_f2
    s_mov_b64 exec, 1
    s_cmp_eq_u32 s27, 2
    s_cbranch_scc0 ps_65
    buffer_store_dwordx4 v[100:103], v247, s[60:63], s23 offen offset:1072
pe_66:
L_f2:
    s_endpgm
L_w2_0:
    v_and_b32_dpp v84, v80, v4 quad_perm:[0,0,0,0] row_mask:0xf bank_mask:0xf
    v_and_b32_dpp v85, v80, v5 quad_perm:[0,0,0,0] row_mask:0xf bank_mask:0xf
    v_and_b32_dpp v86, v81, v6 quad_perm:[3,3,3,3] row_mask:0xf bank_mask:0xf
    v_and_b32_dpp v87, v81, v7 quad_perm:[3,3,3,3] row_mask:0xf bank_mask:0xf
    v_and_b32_dpp v88, v80, v4 quad_perm:[1,1,1,1] row_mask:0xf bank_mask:0xf
    v_and_b32_dpp v89, v80, v5 quad_perm:[1,1,1,1] row_mask:0xf bank_mask:0xf
    v_and_b32_dpp v90, v81, v6 quad_perm:[2,2,2,2] row_mask:0xf bank_mask:0xf
    v_and_b32_dpp v91, v81, v7 quad_perm:[2,2,2,2] row_mask:0xf bank_mask:0xf
    v_mfma_f32_16x16x32_bf16 v[236:239], v[84:87], v[40:43], 0
    v_mfma_f32_16x16x32_bf16 v[240:243], v[84:87], v[168:171], 0
    v_mfma_f32_16x16x32_bf16 v[232:235], v[84:87], v[200:203], 0
    v_and_b32_dpp v92, v80, v4 quad_perm:[2,2,2,2] row_mask:0xf bank_mask:0xf
    v_and_b32_dpp v93, v80, v5 quad_perm:[2,2,2,2] row_mask:0xf bank_mask:0xf
    v_and_b32_dpp v94, v81, v6 quad_perm:[1,1,1,1] row_mask:0xf bank_mask:0xf
    v_and_b32_dpp v95, v81, v7 quad_perm:[1,1,1,1] row_mask:0xf bank_mask:0xf
    v_mfma_f32_16x16x32_bf16 v[236:239], v[88:91], v[44:47], v[236:239]
    v_mfma_f32_16x16x32_bf16 v[240:243], v[88:91], v[172:175], v[240:243]
    v_mfma_f32_16x16x32_bf16 v[232:235], v[88:91], v[204:207], v[232:235]
    v_and_b32_dpp v84, v80, v4 quad_perm:[3,3,3,3] row_mask:0xf bank_mask:0xf
    v_and_b32_dpp v85, v80, v5 quad_perm:[3,3,3,3] row_mask:0xf bank_mask:0xf
    v_and_b32_dpp v86, v81, v6 quad_perm:[0,0,0,0] row_mask:0xf bank_mask:0xf
    v_and_b32_dpp v87, v81, v7 quad_perm:[0,0,0,0] row_mask:0xf bank_mask:0xf
    v_mfma_f32_16x16x32_bf16 v[236:239], v[92:95], v[48:51], v[236:239]
    v_mfma_f32_16x16x32_bf16 v[240:243], v[92:95], v[176:179], v[240:243]
    v_mfma_f32_16x16x32_bf16 v[232:235], v[92:95], v[208:211], v[232:235]
    v_and_b32_dpp v88, v81, v4 quad_perm:[3,3,3,3] row_mask:0xf bank_mask:0xf
    v_and_b32_dpp v89, v81, v5 quad_perm:[3,3,3,3] row_mask:0xf bank_mask:0xf
    v_and_b32_dpp v90, v80, v6 quad_perm:[0,0,0,0] row_mask:0xf bank_mask:0xf
    v_and_b32_dpp v91, v80, v7 quad_perm:[0,0,0,0] row_mask:0xf bank_mask:0xf
    v_mfma_f32_16x16x32_bf16 v[236:239], v[84:87], v[52:55], v[236:239]
    v_mfma_f32_16x16x32_bf16 v[240:243], v[84:87], v[180:183], v[240:243]
    v_mfma_f32_16x16x32_bf16 v[232:235], v[84:87], v[212:215], v[232:235]
    v_and_b32_dpp v92, v81, v4 quad_perm:[2,2,2,2] row_mask:0xf bank_mask:0xf
    v_and_b32_dpp v93, v81, v5 quad_perm:[2,2,2,2] row_mask:0xf bank_mask:0xf
    v_and_b32_dpp v94, v80, v6 quad_perm:[1,1,1,1] row_mask:0xf bank_mask:0xf
    v_and_b32_dpp v95, v80, v7 quad_perm:[1,1,1,1] row_mask:0xf bank_mask:0xf
    v_mfma_f32_16x16x32_bf16 v[236:239], v[88:91], v[56:59], v[236:239]
    v_mfma_f32_16x16x32_bf16 v[240:243], v[88:91], v[184:187], v[240:243]
    v_mfma_f32_16x16x32_bf16 v[232:235], v[88:91], v[216:219], v[232:235]
    v_and_b32_dpp v84, v81, v4 quad_perm:[1,1,1,1] row_mask:0xf bank_mask:0xf
    v_and_b32_dpp v85, v81, v5 quad_perm:[1,1,1,1] row_mask:0xf bank_mask:0xf
    v_and_b32_dpp v86, v80, v6 quad_perm:[2,2,2,2] row_mask:0xf bank_mask:0xf
    v_and_b32_dpp v87, v80, v7 quad_perm:[2,2,2,2] row_mask:0xf bank_mask:0xf
    v_mfma_f32_16x16x32_bf16 v[236:239], v[92:95], v[60:63], v[236:239]
    v_mfma_f32_16x16x32_bf16 v[240:243], v[92:95], v[188:191], v[240:243]
    v_mfma_f32_16x16x32_bf16 v[232:235], v[92:95], v[220:223], v[232:235]
    v_and_b32_dpp v88, v81, v4 quad_perm:[0,0,0,0] row_mask:0xf bank_mask:0xf
    v_and_b32_dpp v89, v81, v5 quad_perm:[0,0,0,0] row_mask:0xf bank_mask:0xf
    v_and_b32_dpp v90, v80, v6 quad_perm:[3,3,3,3] row_mask:0xf bank_mask:0xf
    v_and_b32_dpp v91, v80, v7 quad_perm:[3,3,3,3] row_mask:0xf bank_mask:0xf
    v_mfma_f32_16x16x32_bf16 v[236:239], v[84:87], v[64:67], v[236:239]
    v_mfma_f32_16x16x32_bf16 v[240:243], v[84:87], v[192:195], v[240:243]
    v_mfma_f32_16x16x32_bf16 v[232:235], v[84:87], v[224:227], v[232:235]
    v_mfma_f32_16x16x32_bf16 v[236:239], v[88:91], v[68:71], v[236:239]
    v_mfma_f32_16x16x32_bf16 v[240:243], v[88:91], v[196:199], v[240:243]
    v_mfma_f32_16x16x32_bf16 v[232:235], v[88:91], v[228:231], v[232:235]
    s_nop 5
    v_permlane32_swap_b32 v236, v92
    v_permlane32_swap_b32 v237, v93
    v_permlane32_swap_b32 v238, v94
    v_permlane32_swap_b32 v239, v95
    v_permlane32_swap_b32 v240, v84
    v_permlane32_swap_b32 v241, v85
    v_permlane32_swap_b32 v242, v86
    v_permlane32_swap_b32 v243, v87
    v_permlane32_swap_b32 v232, v88
    v_permlane32_swap_b32 v233, v89
    v_permlane32_swap_b32 v234, v90
    v_permlane32_swap_b32 v235, v91
    v_add_f32_dpp v236, v92, v236 row_ror:8 row_mask:0xf bank_mask:0xf
    v_add_f32_dpp v237, v93, v237 row_ror:8 row_mask:0xf bank_mask:0xf
    v_add_f32_dpp v238, v94, v238 row_ror:8 row_mask:0xf bank_mask:0xf
    v_add_f32_dpp v239, v95, v239 row_ror:8 row_mask:0xf bank_mask:0xf
    v_add_f32_dpp v240, v84, v240 row_ror:8 row_mask:0xf bank_mask:0xf
    v_add_f32_dpp v241, v85, v241 row_ror:8 row_mask:0xf bank_mask:0xf
    v_add_f32_dpp v242, v86, v242 row_ror:8 row_mask:0xf bank_mask:0xf
    v_add_f32_dpp v243, v87, v243 row_ror:8 row_mask:0xf bank_mask:0xf
    v_add_f32_dpp v232, v88, v232 row_ror:8 row_mask:0xf bank_mask:0xf
    v_add_f32_dpp v233, v89, v233 row_ror:8 row_mask:0xf bank_mask:0xf
    v_add_f32_dpp v234, v90, v234 row_ror:8 row_mask:0xf bank_mask:0xf
    v_add_f32_dpp v235, v91, v235 row_ror:8 row_mask:0xf bank_mask:0xf
    v_perm_b32 v236, v236, v244, s12
    s_mov_b64 exec, 0x00ff00ff
    buffer_store_dwordx4 v[236:239], v246, s[60:63], s97 offen offset:2048 sc1
    s_branch L_w2_1
ps_9:
    buffer_store_dwordx4 v[40:43], v18, s[60:63], s97 offen  sc1
    s_branch pe_10
ps_11:
    buffer_store_dwordx4 v[32:35], v247, s[60:63], s97 offen offset:1024 sc1
    s_branch pe_12
L_s3retry:
    s_sub_u32 s49, s49, 1
    s_cbranch_scc0 L_s3poll
    s_branch L_s3ok
ps_16:
    buffer_store_dwordx4 v[32:35], v247, s[60:63], s70 offen offset:1040 sc1
    s_branch pe_17
L_if:
    s_mov_b32 s27, 1
    s_sleep 4
    s_sub_u32 s68, s68, 1
    s_cbranch_scc0 L_iw
    s_branch L_id
ps_25:
    buffer_store_dwordx4 v[28:31], v246, s[60:63], s97 offen  sc1
    s_branch pe_26
L_gar:
    s_sub_u32 s49, s49, 1
    s_cbranch_scc1 L_gad
    buffer_load_dword v27, v15, s[60:63], s48 offen sc1
    buffer_load_dword v28, v22, s[60:63], s48 offen offset:2048 sc1
    s_branch L_gaw
L_mbr:
    s_sub_u32 s49, s49, 1
    s_cbranch_scc1 L_mbd
    buffer_load_dwordx4 v[32:35], v30, s[60:63], s50 offen sc1
    buffer_load_dwordx4 v[36:39], v31, s[60:63], s50 offen sc1
    s_waitcnt vmcnt(0)
    s_branch L_mbw
ps_63:
    buffer_store_dwordx4 v[100:103], v247, s[60:63], s23 offen offset:1056 sc1
    s_branch pe_64
ps_65:
    buffer_store_dwordx4 v[100:103], v247, s[60:63], s23 offen offset:1072 sc1
    s_branch pe_66
L_exit:
    s_endpgm
.section .rodata,"a"
.p2align 6
.amdhsa_kernel adaLN_cond__sliding_block_cached__mixer_channel_mlp__decode_kernel
.amdhsa_next_free_vgpr 248
.amdhsa_next_free_sgpr 102
.amdhsa_accum_offset 248
.amdhsa_group_segment_fixed_size 0
.amdhsa_kernarg_size 120
.amdhsa_user_sgpr_count 2
.amdhsa_user_sgpr_kernarg_segment_ptr 1
.amdhsa_system_sgpr_workgroup_id_x 1
.amdhsa_float_denorm_mode_32 3
.end_amdhsa_kernel
```
